```python
import torch

def _softmax(x, axis=-1):
    return torch.softmax(x, dim=axis)

def _gelu(x):
    return torch.nn.functional.gelu(x, approximate='tanh')

def _silu(x):
    return torch.nn.functional.silu(x)

def _sigmoid(x):
    return torch.sigmoid(x)

def _layernorm(x, axis=-1, eps=1e-05):
    m = x.mean(dim=axis, keepdim=True)
    v = x.var(dim=axis, keepdim=True, unbiased=False)
    return (x - m) / torch.sqrt(v + eps)

def _scatter_add(tgt, idx, src, axis=0):
    return tgt.clone().index_add_(axis, idx, src)

def _segment_sum(src, seg, n):
    out = torch.zeros((n,) + src.shape[1:], dtype=src.dtype)
    return out.index_add_(0, seg, src)

def _pad(x, pw):
    flat = tuple((v for pair in reversed(pw) for v in pair))
    return torch.nn.functional.pad(x, flat)
kernel_name = 'adaLN_cond__grouped_kv_mqa__glu_gated_swiglu__prompt'

def setup_inputs():

    _w = lambda a: (lambda t: t.to(torch.bfloat16) if t.is_floating_point() else t)(torch.as_tensor(a))

    def _A_setup():
        B, S, D, H = (1, 2048, 512, 32)
        Dh = D // H
        return {'x': _w((lambda *s: torch.randn(*s, dtype=torch.bfloat16) * 0.05)(B, S, D)), 'wq': _w((lambda *s: torch.randn(*s, dtype=torch.bfloat16) * 0.1)(D, H * Dh)), 'wk': _w((lambda *s: torch.randn(*s, dtype=torch.bfloat16) * 0.1)(D, Dh)), 'wv': _w((lambda *s: torch.randn(*s, dtype=torch.bfloat16) * 0.1)(D, Dh)), 'wo': _w((lambda *s: torch.randn(*s, dtype=torch.bfloat16) * 0.1)(H * Dh, D))}
    _A_in = _A_setup()

    def _B_setup():
        B, S, D, F = (1, 2048, 512, 1792)
        return {'x': _w((lambda *s: torch.randn(*s, dtype=torch.bfloat16) * 0.05)(B, S, D)), 'w1': _w((lambda *s: torch.randn(*s, dtype=torch.bfloat16) * 1.6)(D, F) * (2.0 / D) ** 0.5), 'w3': _w((lambda *s: torch.randn(*s, dtype=torch.bfloat16) * 1.6)(D, F) * (2.0 / D) ** 0.5), 'w2': _w((lambda *s: torch.randn(*s, dtype=torch.bfloat16) * 1.6)(F, D) * (2.0 / F) ** 0.5)}
    _B_in = _B_setup()
    return {'A_x': _A_in['x'], 'A_wq': _A_in['wq'], 'A_wk': _A_in['wk'], 'A_wv': _A_in['wv'], 'A_wo': _A_in['wo'], 'B_x': _B_in['x'], 'B_w1': _B_in['w1'], 'B_w3': _B_in['w3'], 'B_w2': _B_in['w2'], 'c': _w((lambda *s: torch.randn(*s, dtype=torch.bfloat16) * 0.2)(1, 512) * 8.0), 'w_mod': _w((lambda *s: torch.randn(*s, dtype=torch.bfloat16) * 0.2)(512, 6 * 512) * 512 ** (-0.5) * 8.0)}

def reference(A_x, A_wq, A_wk, A_wv, A_wo, B_x, B_w1, B_w3, B_w2, c, w_mod):

    def _A_ref(x, wq, wk, wv, wo):
        B, S, D = x.shape
        H = 32
        Dh = D // H
        q = (lambda x, *d: x.permute(*d))((x @ wq).reshape(B, S, H, Dh), 0, 2, 1, 3)
        k = x @ wk
        v = x @ wv
        scores = torch.einsum('bhqd,bkd->bhqk', q, k) * Dh ** (-0.5)
        p = _softmax(scores, axis=-1)
        o = torch.einsum('bhqk,bkd->bhqd', p, v)
        return (lambda x, *d: x.permute(*d))(o, 0, 2, 1, 3).reshape(B, S, H * Dh) @ wo

    def _B_ref(x, w1, w3, w2):
        gate = torch.einsum('bsd,df->bsf', x, w1)
        up = torch.einsum('bsd,df->bsf', x, w3)
        h = _silu(gate) * up
        out = torch.einsum('bsf,fd->bsd', h, w2)
        return out
    x = A_x
    mod = (_silu(c) @ w_mod).reshape(c.shape[0], 6, 1, -1)
    sa, ca, ga, sb, cb, gb = (mod[:, 0].clone(), mod[:, 1].clone(), mod[:, 2].clone(), mod[:, 3].clone(), mod[:, 4].clone(), mod[:, 5].clone())
    h = _layernorm(x, axis=-1) * (1 + ca) + sa
    x = x + ga * _A_ref(h, A_wq, A_wk, A_wv, A_wo)
    h = _layernorm(x, axis=-1) * (1 + cb) + sb
    x = x + gb * _B_ref(h, B_w1, B_w3, B_w2)
    return x
```

```asm
; @launch kernel=k1_kernel grid=(256,1,1) block=(512,1,1) lds=133184
; @launch kernel=k2_kernel grid=(256,1,1) block=(512,1,1) lds=163840
.amdgcn_target "amdgcn-amd-amdhsa--gfx950"
.text
.globl k1_kernel
.p2align 8
.type k1_kernel,@function
k1_kernel:
    s_cmp_ge_u32 s2, 256
    s_cbranch_scc1 k1_end
    s_load_dwordx2 s[4:5], s[0:1], 104
    s_load_dwordx2 s[8:9], s[0:1], 0
    s_load_dwordx2 s[12:13], s[0:1], 8
    s_load_dwordx2 s[44:45], s[0:1], 72
    s_load_dwordx2 s[52:53], s[0:1], 80
    s_load_dwordx2 s[36:37], s[0:1], 96
    v_and_b32 v1, 63, v0
    v_lshrrev_b32 v2, 6, v0
    s_nop 0
    v_readfirstlane_b32 s3, v2
    s_and_b32 s20, s2, 7
    s_lshr_b32 s21, s2, 5
    s_lshl_b32 s21, s21, 3
    s_add_u32 s20, s20, s21
    s_bfe_u32 s21, s2, 0x20003
    v_lshlrev_b32 v3, 4, v1
    v_and_b32 v4, 31, v1
    v_lshlrev_b32 v4, 4, v4
    v_lshrrev_b32 v5, 5, v1
    v_mul_u32_u24 v5, 528, v5
    v_add_u32 v4, v4, v5
    s_waitcnt lgkmcnt(0)
    s_mov_b32 s6, 0x1590000
    s_mov_b32 s7, 0x00020000
    s_cmp_ge_u32 s3, 4
    s_cbranch_scc1 k1_kv
    s_mov_b32 s10, 0x200000
    s_mov_b32 s11, 0x00020000
    s_mov_b32 s14, 0x80000
    s_mov_b32 s15, 0x00020000
    s_lshl_b32 s22, s20, 15
    s_lshl_b32 s23, s3, 13
    s_add_u32 s22, s22, s23
    v_lshlrev_b32 v6, 5, v1
    buffer_load_dwordx4 v[8:11], v3, s[8:11], s22 offen offset:0
    buffer_load_dwordx4 v[12:15], v3, s[8:11], s22 offen offset:1024
    buffer_load_dwordx4 v[16:19], v3, s[8:11], s22 offen offset:2048
    buffer_load_dwordx4 v[20:23], v3, s[8:11], s22 offen offset:3072
    s_add_u32 s22, s22, 4096
    buffer_load_dwordx4 v[24:27], v3, s[8:11], s22 offen offset:0
    buffer_load_dwordx4 v[28:31], v3, s[8:11], s22 offen offset:1024
    buffer_load_dwordx4 v[32:35], v3, s[8:11], s22 offen offset:2048
    buffer_load_dwordx4 v[36:39], v3, s[8:11], s22 offen offset:3072
    s_lshl_b32 s23, s21, 2
    s_add_u32 s23, s23, s3
    s_lshl_b32 s24, s23, 6
    s_lshl_b32 s34, s3, 15
    v_lshrrev_b32 v113, 2, v1
    v_lshlrev_b32 v113, 10, v113
    v_and_b32 v114, 3, v1
    v_lshl_add_u32 v113, v114, 4, v113
    v_lshrrev_b32 v112, 5, v1
    v_lshlrev_b32 v112, 9, v112
    v_bfe_u32 v114, v1, 2, 2
    v_lshl_add_u32 v112, v114, 6, v112
    v_and_b32 v114, 1, v1
    v_lshl_add_u32 v112, v114, 5, v112
    v_and_b32 v114, 16, v1
    v_add_u32 v112, v112, v114
    v_bfe_u32 v114, v1, 1, 1
    v_lshl_add_u32 v112, v114, 3, v112
    v_add_u32 v112, s34, v112
    v_mul_u32_u24 v7, 528, v1
    s_lshl_b32 s25, s3, 7
    v_add_u32 v7, s25, v7
    s_barrier
    s_waitcnt vmcnt(0)
    s_add_u32 m0, s34, 0
    s_nop 0
    buffer_load_dwordx4 v113, s[12:15], s24 offen lds
    s_add_u32 s24, s24, 16384
    s_add_u32 m0, s34, 1024
    s_nop 0
    buffer_load_dwordx4 v113, s[12:15], s24 offen lds
    s_add_u32 s24, s24, 16384
    s_add_u32 m0, s34, 2048
    s_nop 0
    buffer_load_dwordx4 v113, s[12:15], s24 offen lds
    s_add_u32 s24, s24, 16384
    s_add_u32 m0, s34, 3072
    s_nop 0
    buffer_load_dwordx4 v113, s[12:15], s24 offen lds
    s_add_u32 s24, s24, 16384
    s_add_u32 m0, s34, 4096
    s_nop 0
    buffer_load_dwordx4 v113, s[12:15], s24 offen lds
    s_add_u32 s24, s24, 16384
    s_add_u32 m0, s34, 5120
    s_nop 0
    buffer_load_dwordx4 v113, s[12:15], s24 offen lds
    s_add_u32 s24, s24, 16384
    s_add_u32 m0, s34, 6144
    s_nop 0
    buffer_load_dwordx4 v113, s[12:15], s24 offen lds
    s_add_u32 s24, s24, 16384
    s_add_u32 m0, s34, 7168
    s_nop 0
    buffer_load_dwordx4 v113, s[12:15], s24 offen lds
    s_add_u32 s24, s24, 16384
    s_add_u32 m0, s34, 8192
    s_nop 0
    buffer_load_dwordx4 v113, s[12:15], s24 offen lds
    s_add_u32 s24, s24, 16384
    s_add_u32 m0, s34, 9216
    s_nop 0
    buffer_load_dwordx4 v113, s[12:15], s24 offen lds
    s_add_u32 s24, s24, 16384
    s_add_u32 m0, s34, 10240
    s_nop 0
    buffer_load_dwordx4 v113, s[12:15], s24 offen lds
    s_add_u32 s24, s24, 16384
    s_add_u32 m0, s34, 11264
    s_nop 0
    buffer_load_dwordx4 v113, s[12:15], s24 offen lds
    s_add_u32 s24, s24, 16384
    s_add_u32 m0, s34, 12288
    s_nop 0
    buffer_load_dwordx4 v113, s[12:15], s24 offen lds
    s_add_u32 s24, s24, 16384
    s_add_u32 m0, s34, 13312
    s_nop 0
    buffer_load_dwordx4 v113, s[12:15], s24 offen lds
    s_add_u32 s24, s24, 16384
    s_add_u32 m0, s34, 14336
    s_nop 0
    buffer_load_dwordx4 v113, s[12:15], s24 offen lds
    s_add_u32 s24, s24, 16384
    s_add_u32 m0, s34, 15360
    s_nop 0
    buffer_load_dwordx4 v113, s[12:15], s24 offen lds
    s_add_u32 s24, s24, 16384
    v_lshlrev_b32 v40, 16, v8
    v_and_b32 v41, 0xffff0000, v8
    v_lshlrev_b32 v42, 16, v9
    v_and_b32 v43, 0xffff0000, v9
    v_lshlrev_b32 v44, 16, v10
    v_and_b32 v45, 0xffff0000, v10
    v_lshlrev_b32 v46, 16, v11
    v_and_b32 v47, 0xffff0000, v11
    v_lshlrev_b32 v48, 16, v12
    v_and_b32 v49, 0xffff0000, v12
    v_lshlrev_b32 v50, 16, v13
    v_and_b32 v51, 0xffff0000, v13
    v_lshlrev_b32 v52, 16, v14
    v_and_b32 v53, 0xffff0000, v14
    v_lshlrev_b32 v54, 16, v15
    v_and_b32 v55, 0xffff0000, v15
    v_lshlrev_b32 v56, 16, v16
    v_and_b32 v57, 0xffff0000, v16
    v_lshlrev_b32 v58, 16, v17
    v_and_b32 v59, 0xffff0000, v17
    v_lshlrev_b32 v60, 16, v18
    v_and_b32 v61, 0xffff0000, v18
    v_lshlrev_b32 v62, 16, v19
    v_and_b32 v63, 0xffff0000, v19
    v_lshlrev_b32 v64, 16, v20
    v_and_b32 v65, 0xffff0000, v20
    v_lshlrev_b32 v66, 16, v21
    v_and_b32 v67, 0xffff0000, v21
    v_lshlrev_b32 v68, 16, v22
    v_and_b32 v69, 0xffff0000, v22
    v_lshlrev_b32 v70, 16, v23
    v_and_b32 v71, 0xffff0000, v23
    v_add_f32 v72, v40, v41
    v_add_f32 v73, v42, v43
    v_add_f32 v74, v44, v45
    v_add_f32 v75, v46, v47
    v_add_f32 v72, v72, v73
    v_add_f32 v74, v74, v75
    v_add_f32 v72, v72, v74
    v_add_f32 v82, v48, v49
    v_add_f32 v83, v50, v51
    v_add_f32 v84, v52, v53
    v_add_f32 v85, v54, v55
    v_add_f32 v82, v82, v83
    v_add_f32 v84, v84, v85
    v_add_f32 v82, v82, v84
    v_add_f32 v92, v56, v57
    v_add_f32 v93, v58, v59
    v_add_f32 v94, v60, v61
    v_add_f32 v95, v62, v63
    v_add_f32 v92, v92, v93
    v_add_f32 v94, v94, v95
    v_add_f32 v92, v92, v94
    v_add_f32 v102, v64, v65
    v_add_f32 v103, v66, v67
    v_add_f32 v104, v68, v69
    v_add_f32 v105, v70, v71
    v_add_f32 v102, v102, v103
    v_add_f32 v104, v104, v105
    v_add_f32 v102, v102, v104
    v_add_f32_dpp v72, v72, v72 quad_perm:[1,0,3,2] row_mask:0xf bank_mask:0xf
    v_add_f32_dpp v82, v82, v82 quad_perm:[1,0,3,2] row_mask:0xf bank_mask:0xf
    v_add_f32_dpp v92, v92, v92 quad_perm:[1,0,3,2] row_mask:0xf bank_mask:0xf
    v_add_f32_dpp v102, v102, v102 quad_perm:[1,0,3,2] row_mask:0xf bank_mask:0xf
    v_add_f32_dpp v72, v72, v72 quad_perm:[2,3,0,1] row_mask:0xf bank_mask:0xf
    v_add_f32_dpp v82, v82, v82 quad_perm:[2,3,0,1] row_mask:0xf bank_mask:0xf
    v_add_f32_dpp v92, v92, v92 quad_perm:[2,3,0,1] row_mask:0xf bank_mask:0xf
    v_add_f32_dpp v102, v102, v102 quad_perm:[2,3,0,1] row_mask:0xf bank_mask:0xf
    v_add_f32_dpp v72, v72, v72 row_half_mirror row_mask:0xf bank_mask:0xf
    v_add_f32_dpp v82, v82, v82 row_half_mirror row_mask:0xf bank_mask:0xf
    v_add_f32_dpp v92, v92, v92 row_half_mirror row_mask:0xf bank_mask:0xf
    v_add_f32_dpp v102, v102, v102 row_half_mirror row_mask:0xf bank_mask:0xf
    v_add_f32_dpp v72, v72, v72 row_mirror row_mask:0xf bank_mask:0xf
    v_add_f32_dpp v82, v82, v82 row_mirror row_mask:0xf bank_mask:0xf
    v_add_f32_dpp v92, v92, v92 row_mirror row_mask:0xf bank_mask:0xf
    v_add_f32_dpp v102, v102, v102 row_mirror row_mask:0xf bank_mask:0xf
    v_add_f32_dpp v72, v72, v72 row_bcast:15 row_mask:0xa bank_mask:0xf
    v_add_f32_dpp v82, v82, v82 row_bcast:15 row_mask:0xa bank_mask:0xf
    v_add_f32_dpp v92, v92, v92 row_bcast:15 row_mask:0xa bank_mask:0xf
    v_add_f32_dpp v102, v102, v102 row_bcast:15 row_mask:0xa bank_mask:0xf
    v_add_f32_dpp v72, v72, v72 row_bcast:31 row_mask:0xc bank_mask:0xf
    v_add_f32_dpp v82, v82, v82 row_bcast:31 row_mask:0xc bank_mask:0xf
    v_add_f32_dpp v92, v92, v92 row_bcast:31 row_mask:0xc bank_mask:0xf
    v_add_f32_dpp v102, v102, v102 row_bcast:31 row_mask:0xc bank_mask:0xf
    s_nop 0
    v_readlane_b32 s26, v72, 63
    v_readlane_b32 s28, v82, 63
    v_readlane_b32 s30, v92, 63
    v_readlane_b32 s32, v102, 63
    s_nop 1
    v_mov_b32 v72, s26
    v_mul_f32 v72, 0x3b000000, v72
    v_sub_f32 v74, v40, v72
    v_sub_f32 v75, v41, v72
    v_sub_f32 v76, v42, v72
    v_sub_f32 v77, v43, v72
    v_sub_f32 v78, v44, v72
    v_sub_f32 v79, v45, v72
    v_sub_f32 v80, v46, v72
    v_sub_f32 v81, v47, v72
    v_mul_f32 v73, v74, v74
    v_fmac_f32 v73, v75, v75
    v_fmac_f32 v73, v76, v76
    v_fmac_f32 v73, v77, v77
    v_fmac_f32 v73, v78, v78
    v_fmac_f32 v73, v79, v79
    v_fmac_f32 v73, v80, v80
    v_fmac_f32 v73, v81, v81
    v_mov_b32 v82, s28
    v_mul_f32 v82, 0x3b000000, v82
    v_sub_f32 v84, v48, v82
    v_sub_f32 v85, v49, v82
    v_sub_f32 v86, v50, v82
    v_sub_f32 v87, v51, v82
    v_sub_f32 v88, v52, v82
    v_sub_f32 v89, v53, v82
    v_sub_f32 v90, v54, v82
    v_sub_f32 v91, v55, v82
    v_mul_f32 v83, v84, v84
    v_fmac_f32 v83, v85, v85
    v_fmac_f32 v83, v86, v86
    v_fmac_f32 v83, v87, v87
    v_fmac_f32 v83, v88, v88
    v_fmac_f32 v83, v89, v89
    v_fmac_f32 v83, v90, v90
    v_fmac_f32 v83, v91, v91
    v_mov_b32 v92, s30
    v_mul_f32 v92, 0x3b000000, v92
    v_sub_f32 v94, v56, v92
    v_sub_f32 v95, v57, v92
    v_sub_f32 v96, v58, v92
    v_sub_f32 v97, v59, v92
    v_sub_f32 v98, v60, v92
    v_sub_f32 v99, v61, v92
    v_sub_f32 v100, v62, v92
    v_sub_f32 v101, v63, v92
    v_mul_f32 v93, v94, v94
    v_fmac_f32 v93, v95, v95
    v_fmac_f32 v93, v96, v96
    v_fmac_f32 v93, v97, v97
    v_fmac_f32 v93, v98, v98
    v_fmac_f32 v93, v99, v99
    v_fmac_f32 v93, v100, v100
    v_fmac_f32 v93, v101, v101
    v_mov_b32 v102, s32
    v_mul_f32 v102, 0x3b000000, v102
    v_sub_f32 v104, v64, v102
    v_sub_f32 v105, v65, v102
    v_sub_f32 v106, v66, v102
    v_sub_f32 v107, v67, v102
    v_sub_f32 v108, v68, v102
    v_sub_f32 v109, v69, v102
    v_sub_f32 v110, v70, v102
    v_sub_f32 v111, v71, v102
    v_mul_f32 v103, v104, v104
    v_fmac_f32 v103, v105, v105
    v_fmac_f32 v103, v106, v106
    v_fmac_f32 v103, v107, v107
    v_fmac_f32 v103, v108, v108
    v_fmac_f32 v103, v109, v109
    v_fmac_f32 v103, v110, v110
    v_fmac_f32 v103, v111, v111
    v_add_f32_dpp v73, v73, v73 quad_perm:[1,0,3,2] row_mask:0xf bank_mask:0xf
    v_add_f32_dpp v83, v83, v83 quad_perm:[1,0,3,2] row_mask:0xf bank_mask:0xf
    v_add_f32_dpp v93, v93, v93 quad_perm:[1,0,3,2] row_mask:0xf bank_mask:0xf
    v_add_f32_dpp v103, v103, v103 quad_perm:[1,0,3,2] row_mask:0xf bank_mask:0xf
    v_add_f32_dpp v73, v73, v73 quad_perm:[2,3,0,1] row_mask:0xf bank_mask:0xf
    v_add_f32_dpp v83, v83, v83 quad_perm:[2,3,0,1] row_mask:0xf bank_mask:0xf
    v_add_f32_dpp v93, v93, v93 quad_perm:[2,3,0,1] row_mask:0xf bank_mask:0xf
    v_add_f32_dpp v103, v103, v103 quad_perm:[2,3,0,1] row_mask:0xf bank_mask:0xf
    v_add_f32_dpp v73, v73, v73 row_half_mirror row_mask:0xf bank_mask:0xf
    v_add_f32_dpp v83, v83, v83 row_half_mirror row_mask:0xf bank_mask:0xf
    v_add_f32_dpp v93, v93, v93 row_half_mirror row_mask:0xf bank_mask:0xf
    v_add_f32_dpp v103, v103, v103 row_half_mirror row_mask:0xf bank_mask:0xf
    v_add_f32_dpp v73, v73, v73 row_mirror row_mask:0xf bank_mask:0xf
    v_add_f32_dpp v83, v83, v83 row_mirror row_mask:0xf bank_mask:0xf
    v_add_f32_dpp v93, v93, v93 row_mirror row_mask:0xf bank_mask:0xf
    v_add_f32_dpp v103, v103, v103 row_mirror row_mask:0xf bank_mask:0xf
    v_add_f32_dpp v73, v73, v73 row_bcast:15 row_mask:0xa bank_mask:0xf
    v_add_f32_dpp v83, v83, v83 row_bcast:15 row_mask:0xa bank_mask:0xf
    v_add_f32_dpp v93, v93, v93 row_bcast:15 row_mask:0xa bank_mask:0xf
    v_add_f32_dpp v103, v103, v103 row_bcast:15 row_mask:0xa bank_mask:0xf
    v_add_f32_dpp v73, v73, v73 row_bcast:31 row_mask:0xc bank_mask:0xf
    v_add_f32_dpp v83, v83, v83 row_bcast:31 row_mask:0xc bank_mask:0xf
    v_add_f32_dpp v93, v93, v93 row_bcast:31 row_mask:0xc bank_mask:0xf
    v_add_f32_dpp v103, v103, v103 row_bcast:31 row_mask:0xc bank_mask:0xf
    s_nop 0
    v_readlane_b32 s27, v73, 63
    v_readlane_b32 s29, v83, 63
    v_readlane_b32 s31, v93, 63
    v_readlane_b32 s33, v103, 63
    v_cvt_pk_bf16_f32 v72, v72, v72
    v_and_b32 v72, 0xffff0000, v72
    v_sub_f32 v74, v40, v72
    v_sub_f32 v75, v41, v72
    v_sub_f32 v76, v42, v72
    v_sub_f32 v77, v43, v72
    v_sub_f32 v78, v44, v72
    v_sub_f32 v79, v45, v72
    v_sub_f32 v80, v46, v72
    v_sub_f32 v81, v47, v72
    v_cvt_pk_bf16_f32 v8, v74, v75
    v_cvt_pk_bf16_f32 v9, v76, v77
    v_cvt_pk_bf16_f32 v10, v78, v79
    v_cvt_pk_bf16_f32 v11, v80, v81
    v_lshlrev_b32 v74, 16, v8
    v_and_b32 v75, 0xffff0000, v8
    v_lshlrev_b32 v76, 16, v9
    v_and_b32 v77, 0xffff0000, v9
    v_lshlrev_b32 v78, 16, v10
    v_and_b32 v79, 0xffff0000, v10
    v_lshlrev_b32 v80, 16, v11
    v_and_b32 v81, 0xffff0000, v11
    v_mov_b32 v73, s27
    v_mul_f32 v73, 0x3b000000, v73
    v_cvt_pk_bf16_f32 v73, v73, v73
    v_and_b32 v73, 0xffff0000, v73
    v_add_f32 v73, 0x3727c5ac, v73
    v_cvt_pk_bf16_f32 v73, v73, v73
    v_and_b32 v73, 0xffff0000, v73
    v_sqrt_f32 v73, v73
    s_nop 0
    v_cvt_pk_bf16_f32 v73, v73, v73
    v_and_b32 v73, 0xffff0000, v73
    v_rcp_f32 v73, v73
    s_nop 0
    v_mul_f32 v74, v74, v73
    v_mul_f32 v75, v75, v73
    v_mul_f32 v76, v76, v73
    v_mul_f32 v77, v77, v73
    v_mul_f32 v78, v78, v73
    v_mul_f32 v79, v79, v73
    v_mul_f32 v80, v80, v73
    v_mul_f32 v81, v81, v73
    v_cvt_pk_bf16_f32 v8, v74, v75
    v_cvt_pk_bf16_f32 v9, v76, v77
    v_cvt_pk_bf16_f32 v10, v78, v79
    v_cvt_pk_bf16_f32 v11, v80, v81
    v_cvt_pk_bf16_f32 v82, v82, v82
    v_and_b32 v82, 0xffff0000, v82
    v_sub_f32 v84, v48, v82
    v_sub_f32 v85, v49, v82
    v_sub_f32 v86, v50, v82
    v_sub_f32 v87, v51, v82
    v_sub_f32 v88, v52, v82
    v_sub_f32 v89, v53, v82
    v_sub_f32 v90, v54, v82
    v_sub_f32 v91, v55, v82
    v_cvt_pk_bf16_f32 v12, v84, v85
    v_cvt_pk_bf16_f32 v13, v86, v87
    v_cvt_pk_bf16_f32 v14, v88, v89
    v_cvt_pk_bf16_f32 v15, v90, v91
    v_lshlrev_b32 v84, 16, v12
    v_and_b32 v85, 0xffff0000, v12
    v_lshlrev_b32 v86, 16, v13
    v_and_b32 v87, 0xffff0000, v13
    v_lshlrev_b32 v88, 16, v14
    v_and_b32 v89, 0xffff0000, v14
    v_lshlrev_b32 v90, 16, v15
    v_and_b32 v91, 0xffff0000, v15
    v_mov_b32 v83, s29
    v_mul_f32 v83, 0x3b000000, v83
    v_cvt_pk_bf16_f32 v83, v83, v83
    v_and_b32 v83, 0xffff0000, v83
    v_add_f32 v83, 0x3727c5ac, v83
    v_cvt_pk_bf16_f32 v83, v83, v83
    v_and_b32 v83, 0xffff0000, v83
    v_sqrt_f32 v83, v83
    s_nop 0
    v_cvt_pk_bf16_f32 v83, v83, v83
    v_and_b32 v83, 0xffff0000, v83
    v_rcp_f32 v83, v83
    s_nop 0
    v_mul_f32 v84, v84, v83
    v_mul_f32 v85, v85, v83
    v_mul_f32 v86, v86, v83
    v_mul_f32 v87, v87, v83
    v_mul_f32 v88, v88, v83
    v_mul_f32 v89, v89, v83
    v_mul_f32 v90, v90, v83
    v_mul_f32 v91, v91, v83
    v_cvt_pk_bf16_f32 v12, v84, v85
    v_cvt_pk_bf16_f32 v13, v86, v87
    v_cvt_pk_bf16_f32 v14, v88, v89
    v_cvt_pk_bf16_f32 v15, v90, v91
    v_cvt_pk_bf16_f32 v92, v92, v92
    v_and_b32 v92, 0xffff0000, v92
    v_sub_f32 v94, v56, v92
    v_sub_f32 v95, v57, v92
    v_sub_f32 v96, v58, v92
    v_sub_f32 v97, v59, v92
    v_sub_f32 v98, v60, v92
    v_sub_f32 v99, v61, v92
    v_sub_f32 v100, v62, v92
    v_sub_f32 v101, v63, v92
    v_cvt_pk_bf16_f32 v16, v94, v95
    v_cvt_pk_bf16_f32 v17, v96, v97
    v_cvt_pk_bf16_f32 v18, v98, v99
    v_cvt_pk_bf16_f32 v19, v100, v101
    v_lshlrev_b32 v94, 16, v16
    v_and_b32 v95, 0xffff0000, v16
    v_lshlrev_b32 v96, 16, v17
    v_and_b32 v97, 0xffff0000, v17
    v_lshlrev_b32 v98, 16, v18
    v_and_b32 v99, 0xffff0000, v18
    v_lshlrev_b32 v100, 16, v19
    v_and_b32 v101, 0xffff0000, v19
    v_mov_b32 v93, s31
    v_mul_f32 v93, 0x3b000000, v93
    v_cvt_pk_bf16_f32 v93, v93, v93
    v_and_b32 v93, 0xffff0000, v93
    v_add_f32 v93, 0x3727c5ac, v93
    v_cvt_pk_bf16_f32 v93, v93, v93
    v_and_b32 v93, 0xffff0000, v93
    v_sqrt_f32 v93, v93
    s_nop 0
    v_cvt_pk_bf16_f32 v93, v93, v93
    v_and_b32 v93, 0xffff0000, v93
    v_rcp_f32 v93, v93
    s_nop 0
    v_mul_f32 v94, v94, v93
    v_mul_f32 v95, v95, v93
    v_mul_f32 v96, v96, v93
    v_mul_f32 v97, v97, v93
    v_mul_f32 v98, v98, v93
    v_mul_f32 v99, v99, v93
    v_mul_f32 v100, v100, v93
    v_mul_f32 v101, v101, v93
    v_cvt_pk_bf16_f32 v16, v94, v95
    v_cvt_pk_bf16_f32 v17, v96, v97
    v_cvt_pk_bf16_f32 v18, v98, v99
    v_cvt_pk_bf16_f32 v19, v100, v101
    v_cvt_pk_bf16_f32 v102, v102, v102
    v_and_b32 v102, 0xffff0000, v102
    v_sub_f32 v104, v64, v102
    v_sub_f32 v105, v65, v102
    v_sub_f32 v106, v66, v102
    v_sub_f32 v107, v67, v102
    v_sub_f32 v108, v68, v102
    v_sub_f32 v109, v69, v102
    v_sub_f32 v110, v70, v102
    v_sub_f32 v111, v71, v102
    v_cvt_pk_bf16_f32 v20, v104, v105
    v_cvt_pk_bf16_f32 v21, v106, v107
    v_cvt_pk_bf16_f32 v22, v108, v109
    v_cvt_pk_bf16_f32 v23, v110, v111
    v_lshlrev_b32 v104, 16, v20
    v_and_b32 v105, 0xffff0000, v20
    v_lshlrev_b32 v106, 16, v21
    v_and_b32 v107, 0xffff0000, v21
    v_lshlrev_b32 v108, 16, v22
    v_and_b32 v109, 0xffff0000, v22
    v_lshlrev_b32 v110, 16, v23
    v_and_b32 v111, 0xffff0000, v23
    v_mov_b32 v103, s33
    v_mul_f32 v103, 0x3b000000, v103
    v_cvt_pk_bf16_f32 v103, v103, v103
    v_and_b32 v103, 0xffff0000, v103
    v_add_f32 v103, 0x3727c5ac, v103
    v_cvt_pk_bf16_f32 v103, v103, v103
    v_and_b32 v103, 0xffff0000, v103
    v_sqrt_f32 v103, v103
    s_nop 0
    v_cvt_pk_bf16_f32 v103, v103, v103
    v_and_b32 v103, 0xffff0000, v103
    v_rcp_f32 v103, v103
    s_nop 0
    v_mul_f32 v104, v104, v103
    v_mul_f32 v105, v105, v103
    v_mul_f32 v106, v106, v103
    v_mul_f32 v107, v107, v103
    v_mul_f32 v108, v108, v103
    v_mul_f32 v109, v109, v103
    v_mul_f32 v110, v110, v103
    v_mul_f32 v111, v111, v103
    v_cvt_pk_bf16_f32 v20, v104, v105
    v_cvt_pk_bf16_f32 v21, v106, v107
    v_cvt_pk_bf16_f32 v22, v108, v109
    v_cvt_pk_bf16_f32 v23, v110, v111
    s_add_u32 m0, s34, 16384
    s_nop 0
    buffer_load_dwordx4 v113, s[12:15], s24 offen lds
    s_add_u32 s24, s24, 16384
    s_add_u32 m0, s34, 17408
    s_nop 0
    buffer_load_dwordx4 v113, s[12:15], s24 offen lds
    s_add_u32 s24, s24, 16384
    s_add_u32 m0, s34, 18432
    s_nop 0
    buffer_load_dwordx4 v113, s[12:15], s24 offen lds
    s_add_u32 s24, s24, 16384
    s_add_u32 m0, s34, 19456
    s_nop 0
    buffer_load_dwordx4 v113, s[12:15], s24 offen lds
    s_add_u32 s24, s24, 16384
    s_add_u32 m0, s34, 20480
    s_nop 0
    buffer_load_dwordx4 v113, s[12:15], s24 offen lds
    s_add_u32 s24, s24, 16384
    s_add_u32 m0, s34, 21504
    s_nop 0
    buffer_load_dwordx4 v113, s[12:15], s24 offen lds
    s_add_u32 s24, s24, 16384
    s_add_u32 m0, s34, 22528
    s_nop 0
    buffer_load_dwordx4 v113, s[12:15], s24 offen lds
    s_add_u32 s24, s24, 16384
    s_add_u32 m0, s34, 23552
    s_nop 0
    buffer_load_dwordx4 v113, s[12:15], s24 offen lds
    s_add_u32 s24, s24, 16384
    s_add_u32 m0, s34, 24576
    s_nop 0
    buffer_load_dwordx4 v113, s[12:15], s24 offen lds
    s_add_u32 s24, s24, 16384
    s_add_u32 m0, s34, 25600
    s_nop 0
    buffer_load_dwordx4 v113, s[12:15], s24 offen lds
    s_add_u32 s24, s24, 16384
    s_add_u32 m0, s34, 26624
    s_nop 0
    buffer_load_dwordx4 v113, s[12:15], s24 offen lds
    s_add_u32 s24, s24, 16384
    s_add_u32 m0, s34, 27648
    s_nop 0
    buffer_load_dwordx4 v113, s[12:15], s24 offen lds
    s_add_u32 s24, s24, 16384
    s_add_u32 m0, s34, 28672
    s_nop 0
    buffer_load_dwordx4 v113, s[12:15], s24 offen lds
    s_add_u32 s24, s24, 16384
    s_add_u32 m0, s34, 29696
    s_nop 0
    buffer_load_dwordx4 v113, s[12:15], s24 offen lds
    s_add_u32 s24, s24, 16384
    s_add_u32 m0, s34, 30720
    s_nop 0
    buffer_load_dwordx4 v113, s[12:15], s24 offen lds
    s_add_u32 s24, s24, 16384
    s_add_u32 m0, s34, 31744
    s_nop 0
    buffer_load_dwordx4 v113, s[12:15], s24 offen lds
    s_add_u32 s24, s24, 16384
    v_lshlrev_b32 v40, 16, v24
    v_and_b32 v41, 0xffff0000, v24
    v_lshlrev_b32 v42, 16, v25
    v_and_b32 v43, 0xffff0000, v25
    v_lshlrev_b32 v44, 16, v26
    v_and_b32 v45, 0xffff0000, v26
    v_lshlrev_b32 v46, 16, v27
    v_and_b32 v47, 0xffff0000, v27
    v_lshlrev_b32 v48, 16, v28
    v_and_b32 v49, 0xffff0000, v28
    v_lshlrev_b32 v50, 16, v29
    v_and_b32 v51, 0xffff0000, v29
    v_lshlrev_b32 v52, 16, v30
    v_and_b32 v53, 0xffff0000, v30
    v_lshlrev_b32 v54, 16, v31
    v_and_b32 v55, 0xffff0000, v31
    v_lshlrev_b32 v56, 16, v32
    v_and_b32 v57, 0xffff0000, v32
    v_lshlrev_b32 v58, 16, v33
    v_and_b32 v59, 0xffff0000, v33
    v_lshlrev_b32 v60, 16, v34
    v_and_b32 v61, 0xffff0000, v34
    v_lshlrev_b32 v62, 16, v35
    v_and_b32 v63, 0xffff0000, v35
    v_lshlrev_b32 v64, 16, v36
    v_and_b32 v65, 0xffff0000, v36
    v_lshlrev_b32 v66, 16, v37
    v_and_b32 v67, 0xffff0000, v37
    v_lshlrev_b32 v68, 16, v38
    v_and_b32 v69, 0xffff0000, v38
    v_lshlrev_b32 v70, 16, v39
    v_and_b32 v71, 0xffff0000, v39
    v_add_f32 v72, v40, v41
    v_add_f32 v73, v42, v43
    v_add_f32 v74, v44, v45
    v_add_f32 v75, v46, v47
    v_add_f32 v72, v72, v73
    v_add_f32 v74, v74, v75
    v_add_f32 v72, v72, v74
    v_add_f32 v82, v48, v49
    v_add_f32 v83, v50, v51
    v_add_f32 v84, v52, v53
    v_add_f32 v85, v54, v55
    v_add_f32 v82, v82, v83
    v_add_f32 v84, v84, v85
    v_add_f32 v82, v82, v84
    v_add_f32 v92, v56, v57
    v_add_f32 v93, v58, v59
    v_add_f32 v94, v60, v61
    v_add_f32 v95, v62, v63
    v_add_f32 v92, v92, v93
    v_add_f32 v94, v94, v95
    v_add_f32 v92, v92, v94
    v_add_f32 v102, v64, v65
    v_add_f32 v103, v66, v67
    v_add_f32 v104, v68, v69
    v_add_f32 v105, v70, v71
    v_add_f32 v102, v102, v103
    v_add_f32 v104, v104, v105
    v_add_f32 v102, v102, v104
    v_add_f32_dpp v72, v72, v72 quad_perm:[1,0,3,2] row_mask:0xf bank_mask:0xf
    v_add_f32_dpp v82, v82, v82 quad_perm:[1,0,3,2] row_mask:0xf bank_mask:0xf
    v_add_f32_dpp v92, v92, v92 quad_perm:[1,0,3,2] row_mask:0xf bank_mask:0xf
    v_add_f32_dpp v102, v102, v102 quad_perm:[1,0,3,2] row_mask:0xf bank_mask:0xf
    v_add_f32_dpp v72, v72, v72 quad_perm:[2,3,0,1] row_mask:0xf bank_mask:0xf
    v_add_f32_dpp v82, v82, v82 quad_perm:[2,3,0,1] row_mask:0xf bank_mask:0xf
    v_add_f32_dpp v92, v92, v92 quad_perm:[2,3,0,1] row_mask:0xf bank_mask:0xf
    v_add_f32_dpp v102, v102, v102 quad_perm:[2,3,0,1] row_mask:0xf bank_mask:0xf
    v_add_f32_dpp v72, v72, v72 row_half_mirror row_mask:0xf bank_mask:0xf
    v_add_f32_dpp v82, v82, v82 row_half_mirror row_mask:0xf bank_mask:0xf
    v_add_f32_dpp v92, v92, v92 row_half_mirror row_mask:0xf bank_mask:0xf
    v_add_f32_dpp v102, v102, v102 row_half_mirror row_mask:0xf bank_mask:0xf
    v_add_f32_dpp v72, v72, v72 row_mirror row_mask:0xf bank_mask:0xf
    v_add_f32_dpp v82, v82, v82 row_mirror row_mask:0xf bank_mask:0xf
    v_add_f32_dpp v92, v92, v92 row_mirror row_mask:0xf bank_mask:0xf
    v_add_f32_dpp v102, v102, v102 row_mirror row_mask:0xf bank_mask:0xf
    v_add_f32_dpp v72, v72, v72 row_bcast:15 row_mask:0xa bank_mask:0xf
    v_add_f32_dpp v82, v82, v82 row_bcast:15 row_mask:0xa bank_mask:0xf
    v_add_f32_dpp v92, v92, v92 row_bcast:15 row_mask:0xa bank_mask:0xf
    v_add_f32_dpp v102, v102, v102 row_bcast:15 row_mask:0xa bank_mask:0xf
    v_add_f32_dpp v72, v72, v72 row_bcast:31 row_mask:0xc bank_mask:0xf
    v_add_f32_dpp v82, v82, v82 row_bcast:31 row_mask:0xc bank_mask:0xf
    v_add_f32_dpp v92, v92, v92 row_bcast:31 row_mask:0xc bank_mask:0xf
    v_add_f32_dpp v102, v102, v102 row_bcast:31 row_mask:0xc bank_mask:0xf
    s_nop 0
    v_readlane_b32 s26, v72, 63
    v_readlane_b32 s28, v82, 63
    v_readlane_b32 s30, v92, 63
    v_readlane_b32 s32, v102, 63
    s_nop 1
    v_mov_b32 v72, s26
    v_mul_f32 v72, 0x3b000000, v72
    v_sub_f32 v74, v40, v72
    v_sub_f32 v75, v41, v72
    v_sub_f32 v76, v42, v72
    v_sub_f32 v77, v43, v72
    v_sub_f32 v78, v44, v72
    v_sub_f32 v79, v45, v72
    v_sub_f32 v80, v46, v72
    v_sub_f32 v81, v47, v72
    v_mul_f32 v73, v74, v74
    v_fmac_f32 v73, v75, v75
    v_fmac_f32 v73, v76, v76
    v_fmac_f32 v73, v77, v77
    v_fmac_f32 v73, v78, v78
    v_fmac_f32 v73, v79, v79
    v_fmac_f32 v73, v80, v80
    v_fmac_f32 v73, v81, v81
    v_mov_b32 v82, s28
    v_mul_f32 v82, 0x3b000000, v82
    v_sub_f32 v84, v48, v82
    v_sub_f32 v85, v49, v82
    v_sub_f32 v86, v50, v82
    v_sub_f32 v87, v51, v82
    v_sub_f32 v88, v52, v82
    v_sub_f32 v89, v53, v82
    v_sub_f32 v90, v54, v82
    v_sub_f32 v91, v55, v82
    v_mul_f32 v83, v84, v84
    v_fmac_f32 v83, v85, v85
    v_fmac_f32 v83, v86, v86
    v_fmac_f32 v83, v87, v87
    v_fmac_f32 v83, v88, v88
    v_fmac_f32 v83, v89, v89
    v_fmac_f32 v83, v90, v90
    v_fmac_f32 v83, v91, v91
    v_mov_b32 v92, s30
    v_mul_f32 v92, 0x3b000000, v92
    v_sub_f32 v94, v56, v92
    v_sub_f32 v95, v57, v92
    v_sub_f32 v96, v58, v92
    v_sub_f32 v97, v59, v92
    v_sub_f32 v98, v60, v92
    v_sub_f32 v99, v61, v92
    v_sub_f32 v100, v62, v92
    v_sub_f32 v101, v63, v92
    v_mul_f32 v93, v94, v94
    v_fmac_f32 v93, v95, v95
    v_fmac_f32 v93, v96, v96
    v_fmac_f32 v93, v97, v97
    v_fmac_f32 v93, v98, v98
    v_fmac_f32 v93, v99, v99
    v_fmac_f32 v93, v100, v100
    v_fmac_f32 v93, v101, v101
    v_mov_b32 v102, s32
    v_mul_f32 v102, 0x3b000000, v102
    v_sub_f32 v104, v64, v102
    v_sub_f32 v105, v65, v102
    v_sub_f32 v106, v66, v102
    v_sub_f32 v107, v67, v102
    v_sub_f32 v108, v68, v102
    v_sub_f32 v109, v69, v102
    v_sub_f32 v110, v70, v102
    v_sub_f32 v111, v71, v102
    v_mul_f32 v103, v104, v104
    v_fmac_f32 v103, v105, v105
    v_fmac_f32 v103, v106, v106
    v_fmac_f32 v103, v107, v107
    v_fmac_f32 v103, v108, v108
    v_fmac_f32 v103, v109, v109
    v_fmac_f32 v103, v110, v110
    v_fmac_f32 v103, v111, v111
    v_add_f32_dpp v73, v73, v73 quad_perm:[1,0,3,2] row_mask:0xf bank_mask:0xf
    v_add_f32_dpp v83, v83, v83 quad_perm:[1,0,3,2] row_mask:0xf bank_mask:0xf
    v_add_f32_dpp v93, v93, v93 quad_perm:[1,0,3,2] row_mask:0xf bank_mask:0xf
    v_add_f32_dpp v103, v103, v103 quad_perm:[1,0,3,2] row_mask:0xf bank_mask:0xf
    v_add_f32_dpp v73, v73, v73 quad_perm:[2,3,0,1] row_mask:0xf bank_mask:0xf
    v_add_f32_dpp v83, v83, v83 quad_perm:[2,3,0,1] row_mask:0xf bank_mask:0xf
    v_add_f32_dpp v93, v93, v93 quad_perm:[2,3,0,1] row_mask:0xf bank_mask:0xf
    v_add_f32_dpp v103, v103, v103 quad_perm:[2,3,0,1] row_mask:0xf bank_mask:0xf
    v_add_f32_dpp v73, v73, v73 row_half_mirror row_mask:0xf bank_mask:0xf
    v_add_f32_dpp v83, v83, v83 row_half_mirror row_mask:0xf bank_mask:0xf
    v_add_f32_dpp v93, v93, v93 row_half_mirror row_mask:0xf bank_mask:0xf
    v_add_f32_dpp v103, v103, v103 row_half_mirror row_mask:0xf bank_mask:0xf
    v_add_f32_dpp v73, v73, v73 row_mirror row_mask:0xf bank_mask:0xf
    v_add_f32_dpp v83, v83, v83 row_mirror row_mask:0xf bank_mask:0xf
    v_add_f32_dpp v93, v93, v93 row_mirror row_mask:0xf bank_mask:0xf
    v_add_f32_dpp v103, v103, v103 row_mirror row_mask:0xf bank_mask:0xf
    v_add_f32_dpp v73, v73, v73 row_bcast:15 row_mask:0xa bank_mask:0xf
    v_add_f32_dpp v83, v83, v83 row_bcast:15 row_mask:0xa bank_mask:0xf
    v_add_f32_dpp v93, v93, v93 row_bcast:15 row_mask:0xa bank_mask:0xf
    v_add_f32_dpp v103, v103, v103 row_bcast:15 row_mask:0xa bank_mask:0xf
    v_add_f32_dpp v73, v73, v73 row_bcast:31 row_mask:0xc bank_mask:0xf
    v_add_f32_dpp v83, v83, v83 row_bcast:31 row_mask:0xc bank_mask:0xf
    v_add_f32_dpp v93, v93, v93 row_bcast:31 row_mask:0xc bank_mask:0xf
    v_add_f32_dpp v103, v103, v103 row_bcast:31 row_mask:0xc bank_mask:0xf
    s_nop 0
    v_readlane_b32 s27, v73, 63
    v_readlane_b32 s29, v83, 63
    v_readlane_b32 s31, v93, 63
    v_readlane_b32 s33, v103, 63
    v_cvt_pk_bf16_f32 v72, v72, v72
    v_and_b32 v72, 0xffff0000, v72
    v_sub_f32 v74, v40, v72
    v_sub_f32 v75, v41, v72
    v_sub_f32 v76, v42, v72
    v_sub_f32 v77, v43, v72
    v_sub_f32 v78, v44, v72
    v_sub_f32 v79, v45, v72
    v_sub_f32 v80, v46, v72
    v_sub_f32 v81, v47, v72
    v_cvt_pk_bf16_f32 v24, v74, v75
    v_cvt_pk_bf16_f32 v25, v76, v77
    v_cvt_pk_bf16_f32 v26, v78, v79
    v_cvt_pk_bf16_f32 v27, v80, v81
    v_lshlrev_b32 v74, 16, v24
    v_and_b32 v75, 0xffff0000, v24
    v_lshlrev_b32 v76, 16, v25
    v_and_b32 v77, 0xffff0000, v25
    v_lshlrev_b32 v78, 16, v26
    v_and_b32 v79, 0xffff0000, v26
    v_lshlrev_b32 v80, 16, v27
    v_and_b32 v81, 0xffff0000, v27
    v_mov_b32 v73, s27
    v_mul_f32 v73, 0x3b000000, v73
    v_cvt_pk_bf16_f32 v73, v73, v73
    v_and_b32 v73, 0xffff0000, v73
    v_add_f32 v73, 0x3727c5ac, v73
    v_cvt_pk_bf16_f32 v73, v73, v73
    v_and_b32 v73, 0xffff0000, v73
    v_sqrt_f32 v73, v73
    s_nop 0
    v_cvt_pk_bf16_f32 v73, v73, v73
    v_and_b32 v73, 0xffff0000, v73
    v_rcp_f32 v73, v73
    s_nop 0
    v_mul_f32 v74, v74, v73
    v_mul_f32 v75, v75, v73
    v_mul_f32 v76, v76, v73
    v_mul_f32 v77, v77, v73
    v_mul_f32 v78, v78, v73
    v_mul_f32 v79, v79, v73
    v_mul_f32 v80, v80, v73
    v_mul_f32 v81, v81, v73
    v_cvt_pk_bf16_f32 v24, v74, v75
    v_cvt_pk_bf16_f32 v25, v76, v77
    v_cvt_pk_bf16_f32 v26, v78, v79
    v_cvt_pk_bf16_f32 v27, v80, v81
    v_cvt_pk_bf16_f32 v82, v82, v82
    v_and_b32 v82, 0xffff0000, v82
    v_sub_f32 v84, v48, v82
    v_sub_f32 v85, v49, v82
    v_sub_f32 v86, v50, v82
    v_sub_f32 v87, v51, v82
    v_sub_f32 v88, v52, v82
    v_sub_f32 v89, v53, v82
    v_sub_f32 v90, v54, v82
    v_sub_f32 v91, v55, v82
    v_cvt_pk_bf16_f32 v28, v84, v85
    v_cvt_pk_bf16_f32 v29, v86, v87
    v_cvt_pk_bf16_f32 v30, v88, v89
    v_cvt_pk_bf16_f32 v31, v90, v91
    v_lshlrev_b32 v84, 16, v28
    v_and_b32 v85, 0xffff0000, v28
    v_lshlrev_b32 v86, 16, v29
    v_and_b32 v87, 0xffff0000, v29
    v_lshlrev_b32 v88, 16, v30
    v_and_b32 v89, 0xffff0000, v30
    v_lshlrev_b32 v90, 16, v31
    v_and_b32 v91, 0xffff0000, v31
    v_mov_b32 v83, s29
    v_mul_f32 v83, 0x3b000000, v83
    v_cvt_pk_bf16_f32 v83, v83, v83
    v_and_b32 v83, 0xffff0000, v83
    v_add_f32 v83, 0x3727c5ac, v83
    v_cvt_pk_bf16_f32 v83, v83, v83
    v_and_b32 v83, 0xffff0000, v83
    v_sqrt_f32 v83, v83
    s_nop 0
    v_cvt_pk_bf16_f32 v83, v83, v83
    v_and_b32 v83, 0xffff0000, v83
    v_rcp_f32 v83, v83
    s_nop 0
    v_mul_f32 v84, v84, v83
    v_mul_f32 v85, v85, v83
    v_mul_f32 v86, v86, v83
    v_mul_f32 v87, v87, v83
    v_mul_f32 v88, v88, v83
    v_mul_f32 v89, v89, v83
    v_mul_f32 v90, v90, v83
    v_mul_f32 v91, v91, v83
    v_cvt_pk_bf16_f32 v28, v84, v85
    v_cvt_pk_bf16_f32 v29, v86, v87
    v_cvt_pk_bf16_f32 v30, v88, v89
    v_cvt_pk_bf16_f32 v31, v90, v91
    v_cvt_pk_bf16_f32 v92, v92, v92
    v_and_b32 v92, 0xffff0000, v92
    v_sub_f32 v94, v56, v92
    v_sub_f32 v95, v57, v92
    v_sub_f32 v96, v58, v92
    v_sub_f32 v97, v59, v92
    v_sub_f32 v98, v60, v92
    v_sub_f32 v99, v61, v92
    v_sub_f32 v100, v62, v92
    v_sub_f32 v101, v63, v92
    v_cvt_pk_bf16_f32 v32, v94, v95
    v_cvt_pk_bf16_f32 v33, v96, v97
    v_cvt_pk_bf16_f32 v34, v98, v99
    v_cvt_pk_bf16_f32 v35, v100, v101
    v_lshlrev_b32 v94, 16, v32
    v_and_b32 v95, 0xffff0000, v32
    v_lshlrev_b32 v96, 16, v33
    v_and_b32 v97, 0xffff0000, v33
    v_lshlrev_b32 v98, 16, v34
    v_and_b32 v99, 0xffff0000, v34
    v_lshlrev_b32 v100, 16, v35
    v_and_b32 v101, 0xffff0000, v35
    v_mov_b32 v93, s31
    v_mul_f32 v93, 0x3b000000, v93
    v_cvt_pk_bf16_f32 v93, v93, v93
    v_and_b32 v93, 0xffff0000, v93
    v_add_f32 v93, 0x3727c5ac, v93
    v_cvt_pk_bf16_f32 v93, v93, v93
    v_and_b32 v93, 0xffff0000, v93
    v_sqrt_f32 v93, v93
    s_nop 0
    v_cvt_pk_bf16_f32 v93, v93, v93
    v_and_b32 v93, 0xffff0000, v93
    v_rcp_f32 v93, v93
    s_nop 0
    v_mul_f32 v94, v94, v93
    v_mul_f32 v95, v95, v93
    v_mul_f32 v96, v96, v93
    v_mul_f32 v97, v97, v93
    v_mul_f32 v98, v98, v93
    v_mul_f32 v99, v99, v93
    v_mul_f32 v100, v100, v93
    v_mul_f32 v101, v101, v93
    v_cvt_pk_bf16_f32 v32, v94, v95
    v_cvt_pk_bf16_f32 v33, v96, v97
    v_cvt_pk_bf16_f32 v34, v98, v99
    v_cvt_pk_bf16_f32 v35, v100, v101
    v_cvt_pk_bf16_f32 v102, v102, v102
    v_and_b32 v102, 0xffff0000, v102
    v_sub_f32 v104, v64, v102
    v_sub_f32 v105, v65, v102
    v_sub_f32 v106, v66, v102
    v_sub_f32 v107, v67, v102
    v_sub_f32 v108, v68, v102
    v_sub_f32 v109, v69, v102
    v_sub_f32 v110, v70, v102
    v_sub_f32 v111, v71, v102
    v_cvt_pk_bf16_f32 v36, v104, v105
    v_cvt_pk_bf16_f32 v37, v106, v107
    v_cvt_pk_bf16_f32 v38, v108, v109
    v_cvt_pk_bf16_f32 v39, v110, v111
    v_lshlrev_b32 v104, 16, v36
    v_and_b32 v105, 0xffff0000, v36
    v_lshlrev_b32 v106, 16, v37
    v_and_b32 v107, 0xffff0000, v37
    v_lshlrev_b32 v108, 16, v38
    v_and_b32 v109, 0xffff0000, v38
    v_lshlrev_b32 v110, 16, v39
    v_and_b32 v111, 0xffff0000, v39
    v_mov_b32 v103, s33
    v_mul_f32 v103, 0x3b000000, v103
    v_cvt_pk_bf16_f32 v103, v103, v103
    v_and_b32 v103, 0xffff0000, v103
    v_add_f32 v103, 0x3727c5ac, v103
    v_cvt_pk_bf16_f32 v103, v103, v103
    v_and_b32 v103, 0xffff0000, v103
    v_sqrt_f32 v103, v103
    s_nop 0
    v_cvt_pk_bf16_f32 v103, v103, v103
    v_and_b32 v103, 0xffff0000, v103
    v_rcp_f32 v103, v103
    s_nop 0
    v_mul_f32 v104, v104, v103
    v_mul_f32 v105, v105, v103
    v_mul_f32 v106, v106, v103
    v_mul_f32 v107, v107, v103
    v_mul_f32 v108, v108, v103
    v_mul_f32 v109, v109, v103
    v_mul_f32 v110, v110, v103
    v_mul_f32 v111, v111, v103
    v_cvt_pk_bf16_f32 v36, v104, v105
    v_cvt_pk_bf16_f32 v37, v106, v107
    v_cvt_pk_bf16_f32 v38, v108, v109
    v_cvt_pk_bf16_f32 v39, v110, v111
    s_waitcnt vmcnt(24)
    ds_read_b64_tr_b16 v[128:129], v112 offset:0
    ds_read_b64_tr_b16 v[130:131], v112 offset:256
    ds_read_b64_tr_b16 v[132:133], v112 offset:1024
    ds_read_b64_tr_b16 v[134:135], v112 offset:1280
    ds_read_b64_tr_b16 v[136:137], v112 offset:2048
    ds_read_b64_tr_b16 v[138:139], v112 offset:2304
    ds_read_b64_tr_b16 v[140:141], v112 offset:3072
    ds_read_b64_tr_b16 v[142:143], v112 offset:3328
    s_waitcnt lgkmcnt(4)
    ds_read_b64_tr_b16 v[144:145], v112 offset:4096
    ds_read_b64_tr_b16 v[146:147], v112 offset:4352
    ds_read_b64_tr_b16 v[148:149], v112 offset:5120
    ds_read_b64_tr_b16 v[150:151], v112 offset:5376
    ds_read_b64_tr_b16 v[152:153], v112 offset:6144
    ds_read_b64_tr_b16 v[154:155], v112 offset:6400
    ds_read_b64_tr_b16 v[156:157], v112 offset:7168
    ds_read_b64_tr_b16 v[158:159], v112 offset:7424
    s_waitcnt lgkmcnt(4)
    s_waitcnt vmcnt(16)
    ds_read_b64_tr_b16 v[160:161], v112 offset:8192
    ds_read_b64_tr_b16 v[162:163], v112 offset:8448
    ds_read_b64_tr_b16 v[164:165], v112 offset:9216
    ds_read_b64_tr_b16 v[166:167], v112 offset:9472
    ds_read_b64_tr_b16 v[168:169], v112 offset:10240
    ds_read_b64_tr_b16 v[170:171], v112 offset:10496
    ds_read_b64_tr_b16 v[172:173], v112 offset:11264
    ds_read_b64_tr_b16 v[174:175], v112 offset:11520
    s_waitcnt lgkmcnt(4)
    ds_read_b64_tr_b16 v[176:177], v112 offset:12288
    ds_read_b64_tr_b16 v[178:179], v112 offset:12544
    ds_read_b64_tr_b16 v[180:181], v112 offset:13312
    ds_read_b64_tr_b16 v[182:183], v112 offset:13568
    ds_read_b64_tr_b16 v[184:185], v112 offset:14336
    ds_read_b64_tr_b16 v[186:187], v112 offset:14592
    ds_read_b64_tr_b16 v[188:189], v112 offset:15360
    ds_read_b64_tr_b16 v[190:191], v112 offset:15616
    s_waitcnt lgkmcnt(4)
    s_waitcnt vmcnt(8)
    ds_read_b64_tr_b16 v[192:193], v112 offset:16384
    ds_read_b64_tr_b16 v[194:195], v112 offset:16640
    ds_read_b64_tr_b16 v[196:197], v112 offset:17408
    ds_read_b64_tr_b16 v[198:199], v112 offset:17664
    ds_read_b64_tr_b16 v[200:201], v112 offset:18432
    ds_read_b64_tr_b16 v[202:203], v112 offset:18688
    ds_read_b64_tr_b16 v[204:205], v112 offset:19456
    ds_read_b64_tr_b16 v[206:207], v112 offset:19712
    s_waitcnt lgkmcnt(4)
    ds_read_b64_tr_b16 v[208:209], v112 offset:20480
    ds_read_b64_tr_b16 v[210:211], v112 offset:20736
    ds_read_b64_tr_b16 v[212:213], v112 offset:21504
    ds_read_b64_tr_b16 v[214:215], v112 offset:21760
    ds_read_b64_tr_b16 v[216:217], v112 offset:22528
    ds_read_b64_tr_b16 v[218:219], v112 offset:22784
    ds_read_b64_tr_b16 v[220:221], v112 offset:23552
    ds_read_b64_tr_b16 v[222:223], v112 offset:23808
    s_waitcnt lgkmcnt(4)
    s_waitcnt vmcnt(0)
    ds_read_b64_tr_b16 v[224:225], v112 offset:24576
    ds_read_b64_tr_b16 v[226:227], v112 offset:24832
    ds_read_b64_tr_b16 v[228:229], v112 offset:25600
    ds_read_b64_tr_b16 v[230:231], v112 offset:25856
    ds_read_b64_tr_b16 v[232:233], v112 offset:26624
    ds_read_b64_tr_b16 v[234:235], v112 offset:26880
    ds_read_b64_tr_b16 v[236:237], v112 offset:27648
    ds_read_b64_tr_b16 v[238:239], v112 offset:27904
    s_waitcnt lgkmcnt(4)
    ds_read_b64_tr_b16 v[240:241], v112 offset:28672
    ds_read_b64_tr_b16 v[242:243], v112 offset:28928
    ds_read_b64_tr_b16 v[244:245], v112 offset:29696
    ds_read_b64_tr_b16 v[246:247], v112 offset:29952
    ds_read_b64_tr_b16 v[248:249], v112 offset:30720
    ds_read_b64_tr_b16 v[250:251], v112 offset:30976
    ds_read_b64_tr_b16 v[252:253], v112 offset:31744
    ds_read_b64_tr_b16 v[254:255], v112 offset:32000
    s_waitcnt lgkmcnt(4)
    s_waitcnt lgkmcnt(0)
    v_lshlrev_b32 v56, 16, v8
    v_and_b32 v57, 0xffff0000, v8
    v_lshlrev_b32 v58, 16, v9
    v_and_b32 v59, 0xffff0000, v9
    v_lshlrev_b32 v60, 16, v10
    v_and_b32 v61, 0xffff0000, v10
    v_lshlrev_b32 v62, 16, v11
    v_and_b32 v63, 0xffff0000, v11
    v_lshlrev_b32 v64, 16, v12
    v_and_b32 v65, 0xffff0000, v12
    v_lshlrev_b32 v66, 16, v13
    v_and_b32 v67, 0xffff0000, v13
    v_lshlrev_b32 v68, 16, v14
    v_and_b32 v69, 0xffff0000, v14
    v_lshlrev_b32 v70, 16, v15
    v_and_b32 v71, 0xffff0000, v15
    v_lshlrev_b32 v72, 16, v16
    v_and_b32 v73, 0xffff0000, v16
    v_lshlrev_b32 v74, 16, v17
    v_and_b32 v75, 0xffff0000, v17
    v_lshlrev_b32 v76, 16, v18
    v_and_b32 v77, 0xffff0000, v18
    v_lshlrev_b32 v78, 16, v19
    v_and_b32 v79, 0xffff0000, v19
    v_lshlrev_b32 v80, 16, v20
    v_and_b32 v81, 0xffff0000, v20
    v_lshlrev_b32 v82, 16, v21
    v_and_b32 v83, 0xffff0000, v21
    v_lshlrev_b32 v84, 16, v22
    v_and_b32 v85, 0xffff0000, v22
    v_lshlrev_b32 v86, 16, v23
    v_and_b32 v87, 0xffff0000, v23
    v_lshlrev_b32 v88, 16, v24
    v_and_b32 v89, 0xffff0000, v24
    v_lshlrev_b32 v90, 16, v25
    v_and_b32 v91, 0xffff0000, v25
    v_lshlrev_b32 v92, 16, v26
    v_and_b32 v93, 0xffff0000, v26
    v_lshlrev_b32 v94, 16, v27
    v_and_b32 v95, 0xffff0000, v27
    v_lshlrev_b32 v96, 16, v28
    v_and_b32 v97, 0xffff0000, v28
    v_lshlrev_b32 v98, 16, v29
    v_and_b32 v99, 0xffff0000, v29
    v_lshlrev_b32 v100, 16, v30
    v_and_b32 v101, 0xffff0000, v30
    v_lshlrev_b32 v102, 16, v31
    v_and_b32 v103, 0xffff0000, v31
    v_lshlrev_b32 v104, 16, v32
    v_and_b32 v105, 0xffff0000, v32
    v_lshlrev_b32 v106, 16, v33
    v_and_b32 v107, 0xffff0000, v33
    v_lshlrev_b32 v108, 16, v34
    v_and_b32 v109, 0xffff0000, v34
    v_lshlrev_b32 v110, 16, v35
    v_and_b32 v111, 0xffff0000, v35
    v_lshlrev_b32 v112, 16, v36
    v_and_b32 v113, 0xffff0000, v36
    v_lshlrev_b32 v114, 16, v37
    v_and_b32 v115, 0xffff0000, v37
    v_lshlrev_b32 v116, 16, v38
    v_and_b32 v117, 0xffff0000, v38
    v_lshlrev_b32 v118, 16, v39
    v_and_b32 v119, 0xffff0000, v39
    s_barrier
    s_barrier
    buffer_load_dwordx4 v[48:51], v6, s[4:7], 0 offen offset:2048
    buffer_load_dwordx4 v[52:55], v6, s[4:7], 0 offen offset:2064
    buffer_load_dwordx4 v[40:43], v6, s[4:7], 0 offen
    buffer_load_dwordx4 v[44:47], v6, s[4:7], 0 offen offset:16
    s_waitcnt vmcnt(2)
    v_pk_mul_f32 v[56:57], v[56:57], v[48:49]
    v_pk_mul_f32 v[58:59], v[58:59], v[50:51]
    v_pk_mul_f32 v[60:61], v[60:61], v[52:53]
    v_pk_mul_f32 v[62:63], v[62:63], v[54:55]
    v_cvt_pk_bf16_f32 v8, v56, v57
    v_cvt_pk_bf16_f32 v9, v58, v59
    v_cvt_pk_bf16_f32 v10, v60, v61
    v_cvt_pk_bf16_f32 v11, v62, v63
    v_lshlrev_b32 v56, 16, v8
    v_and_b32 v57, 0xffff0000, v8
    v_lshlrev_b32 v58, 16, v9
    v_and_b32 v59, 0xffff0000, v9
    v_lshlrev_b32 v60, 16, v10
    v_and_b32 v61, 0xffff0000, v10
    v_lshlrev_b32 v62, 16, v11
    v_and_b32 v63, 0xffff0000, v11
    s_waitcnt vmcnt(0)
    v_pk_add_f32 v[56:57], v[56:57], v[40:41]
    v_pk_add_f32 v[58:59], v[58:59], v[42:43]
    v_pk_add_f32 v[60:61], v[60:61], v[44:45]
    v_pk_add_f32 v[62:63], v[62:63], v[46:47]
    v_cvt_pk_bf16_f32 v8, v56, v57
    v_cvt_pk_bf16_f32 v9, v58, v59
    v_cvt_pk_bf16_f32 v10, v60, v61
    v_cvt_pk_bf16_f32 v11, v62, v63
    ds_write_b128 v7, v[8:11] offset:0
    v_pk_mul_f32 v[64:65], v[64:65], v[48:49]
    v_pk_mul_f32 v[66:67], v[66:67], v[50:51]
    v_pk_mul_f32 v[68:69], v[68:69], v[52:53]
    v_pk_mul_f32 v[70:71], v[70:71], v[54:55]
    v_cvt_pk_bf16_f32 v12, v64, v65
    v_cvt_pk_bf16_f32 v13, v66, v67
    v_cvt_pk_bf16_f32 v14, v68, v69
    v_cvt_pk_bf16_f32 v15, v70, v71
    v_lshlrev_b32 v64, 16, v12
    v_and_b32 v65, 0xffff0000, v12
    v_lshlrev_b32 v66, 16, v13
    v_and_b32 v67, 0xffff0000, v13
    v_lshlrev_b32 v68, 16, v14
    v_and_b32 v69, 0xffff0000, v14
    v_lshlrev_b32 v70, 16, v15
    v_and_b32 v71, 0xffff0000, v15
    v_pk_add_f32 v[64:65], v[64:65], v[40:41]
    v_pk_add_f32 v[66:67], v[66:67], v[42:43]
    v_pk_add_f32 v[68:69], v[68:69], v[44:45]
    v_pk_add_f32 v[70:71], v[70:71], v[46:47]
    v_cvt_pk_bf16_f32 v12, v64, v65
    v_cvt_pk_bf16_f32 v13, v66, v67
    v_cvt_pk_bf16_f32 v14, v68, v69
    v_cvt_pk_bf16_f32 v15, v70, v71
    ds_write_b128 v7, v[12:15] offset:16
    v_pk_mul_f32 v[72:73], v[72:73], v[48:49]
    v_pk_mul_f32 v[74:75], v[74:75], v[50:51]
    v_pk_mul_f32 v[76:77], v[76:77], v[52:53]
    v_pk_mul_f32 v[78:79], v[78:79], v[54:55]
    v_cvt_pk_bf16_f32 v16, v72, v73
    v_cvt_pk_bf16_f32 v17, v74, v75
    v_cvt_pk_bf16_f32 v18, v76, v77
    v_cvt_pk_bf16_f32 v19, v78, v79
    v_lshlrev_b32 v72, 16, v16
    v_and_b32 v73, 0xffff0000, v16
    v_lshlrev_b32 v74, 16, v17
    v_and_b32 v75, 0xffff0000, v17
    v_lshlrev_b32 v76, 16, v18
    v_and_b32 v77, 0xffff0000, v18
    v_lshlrev_b32 v78, 16, v19
    v_and_b32 v79, 0xffff0000, v19
    v_pk_add_f32 v[72:73], v[72:73], v[40:41]
    v_pk_add_f32 v[74:75], v[74:75], v[42:43]
    v_pk_add_f32 v[76:77], v[76:77], v[44:45]
    v_pk_add_f32 v[78:79], v[78:79], v[46:47]
    v_cvt_pk_bf16_f32 v16, v72, v73
    v_cvt_pk_bf16_f32 v17, v74, v75
    v_cvt_pk_bf16_f32 v18, v76, v77
    v_cvt_pk_bf16_f32 v19, v78, v79
    ds_write_b128 v7, v[16:19] offset:32
    v_pk_mul_f32 v[80:81], v[80:81], v[48:49]
    v_pk_mul_f32 v[82:83], v[82:83], v[50:51]
    v_pk_mul_f32 v[84:85], v[84:85], v[52:53]
    v_pk_mul_f32 v[86:87], v[86:87], v[54:55]
    v_cvt_pk_bf16_f32 v20, v80, v81
    v_cvt_pk_bf16_f32 v21, v82, v83
    v_cvt_pk_bf16_f32 v22, v84, v85
    v_cvt_pk_bf16_f32 v23, v86, v87
    v_lshlrev_b32 v80, 16, v20
    v_and_b32 v81, 0xffff0000, v20
    v_lshlrev_b32 v82, 16, v21
    v_and_b32 v83, 0xffff0000, v21
    v_lshlrev_b32 v84, 16, v22
    v_and_b32 v85, 0xffff0000, v22
    v_lshlrev_b32 v86, 16, v23
    v_and_b32 v87, 0xffff0000, v23
    v_pk_add_f32 v[80:81], v[80:81], v[40:41]
    v_pk_add_f32 v[82:83], v[82:83], v[42:43]
    v_pk_add_f32 v[84:85], v[84:85], v[44:45]
    v_pk_add_f32 v[86:87], v[86:87], v[46:47]
    v_cvt_pk_bf16_f32 v20, v80, v81
    v_cvt_pk_bf16_f32 v21, v82, v83
    v_cvt_pk_bf16_f32 v22, v84, v85
    v_cvt_pk_bf16_f32 v23, v86, v87
    ds_write_b128 v7, v[20:23] offset:48
    v_pk_mul_f32 v[88:89], v[88:89], v[48:49]
    v_pk_mul_f32 v[90:91], v[90:91], v[50:51]
    v_pk_mul_f32 v[92:93], v[92:93], v[52:53]
    v_pk_mul_f32 v[94:95], v[94:95], v[54:55]
    v_cvt_pk_bf16_f32 v24, v88, v89
    v_cvt_pk_bf16_f32 v25, v90, v91
    v_cvt_pk_bf16_f32 v26, v92, v93
    v_cvt_pk_bf16_f32 v27, v94, v95
    v_lshlrev_b32 v88, 16, v24
    v_and_b32 v89, 0xffff0000, v24
    v_lshlrev_b32 v90, 16, v25
    v_and_b32 v91, 0xffff0000, v25
    v_lshlrev_b32 v92, 16, v26
    v_and_b32 v93, 0xffff0000, v26
    v_lshlrev_b32 v94, 16, v27
    v_and_b32 v95, 0xffff0000, v27
    v_pk_add_f32 v[88:89], v[88:89], v[40:41]
    v_pk_add_f32 v[90:91], v[90:91], v[42:43]
    v_pk_add_f32 v[92:93], v[92:93], v[44:45]
    v_pk_add_f32 v[94:95], v[94:95], v[46:47]
    v_cvt_pk_bf16_f32 v24, v88, v89
    v_cvt_pk_bf16_f32 v25, v90, v91
    v_cvt_pk_bf16_f32 v26, v92, v93
    v_cvt_pk_bf16_f32 v27, v94, v95
    ds_write_b128 v7, v[24:27] offset:64
    v_pk_mul_f32 v[96:97], v[96:97], v[48:49]
    v_pk_mul_f32 v[98:99], v[98:99], v[50:51]
    v_pk_mul_f32 v[100:101], v[100:101], v[52:53]
    v_pk_mul_f32 v[102:103], v[102:103], v[54:55]
    v_cvt_pk_bf16_f32 v28, v96, v97
    v_cvt_pk_bf16_f32 v29, v98, v99
    v_cvt_pk_bf16_f32 v30, v100, v101
    v_cvt_pk_bf16_f32 v31, v102, v103
    v_lshlrev_b32 v96, 16, v28
    v_and_b32 v97, 0xffff0000, v28
    v_lshlrev_b32 v98, 16, v29
    v_and_b32 v99, 0xffff0000, v29
    v_lshlrev_b32 v100, 16, v30
    v_and_b32 v101, 0xffff0000, v30
    v_lshlrev_b32 v102, 16, v31
    v_and_b32 v103, 0xffff0000, v31
    v_pk_add_f32 v[96:97], v[96:97], v[40:41]
    v_pk_add_f32 v[98:99], v[98:99], v[42:43]
    v_pk_add_f32 v[100:101], v[100:101], v[44:45]
    v_pk_add_f32 v[102:103], v[102:103], v[46:47]
    v_cvt_pk_bf16_f32 v28, v96, v97
    v_cvt_pk_bf16_f32 v29, v98, v99
    v_cvt_pk_bf16_f32 v30, v100, v101
    v_cvt_pk_bf16_f32 v31, v102, v103
    ds_write_b128 v7, v[28:31] offset:80
    v_pk_mul_f32 v[104:105], v[104:105], v[48:49]
    v_pk_mul_f32 v[106:107], v[106:107], v[50:51]
    v_pk_mul_f32 v[108:109], v[108:109], v[52:53]
    v_pk_mul_f32 v[110:111], v[110:111], v[54:55]
    v_cvt_pk_bf16_f32 v32, v104, v105
    v_cvt_pk_bf16_f32 v33, v106, v107
    v_cvt_pk_bf16_f32 v34, v108, v109
    v_cvt_pk_bf16_f32 v35, v110, v111
    v_lshlrev_b32 v104, 16, v32
    v_and_b32 v105, 0xffff0000, v32
    v_lshlrev_b32 v106, 16, v33
    v_and_b32 v107, 0xffff0000, v33
    v_lshlrev_b32 v108, 16, v34
    v_and_b32 v109, 0xffff0000, v34
    v_lshlrev_b32 v110, 16, v35
    v_and_b32 v111, 0xffff0000, v35
    v_pk_add_f32 v[104:105], v[104:105], v[40:41]
    v_pk_add_f32 v[106:107], v[106:107], v[42:43]
    v_pk_add_f32 v[108:109], v[108:109], v[44:45]
    v_pk_add_f32 v[110:111], v[110:111], v[46:47]
    v_cvt_pk_bf16_f32 v32, v104, v105
    v_cvt_pk_bf16_f32 v33, v106, v107
    v_cvt_pk_bf16_f32 v34, v108, v109
    v_cvt_pk_bf16_f32 v35, v110, v111
    ds_write_b128 v7, v[32:35] offset:96
    v_pk_mul_f32 v[112:113], v[112:113], v[48:49]
    v_pk_mul_f32 v[114:115], v[114:115], v[50:51]
    v_pk_mul_f32 v[116:117], v[116:117], v[52:53]
    v_pk_mul_f32 v[118:119], v[118:119], v[54:55]
    v_cvt_pk_bf16_f32 v36, v112, v113
    v_cvt_pk_bf16_f32 v37, v114, v115
    v_cvt_pk_bf16_f32 v38, v116, v117
    v_cvt_pk_bf16_f32 v39, v118, v119
    v_lshlrev_b32 v112, 16, v36
    v_and_b32 v113, 0xffff0000, v36
    v_lshlrev_b32 v114, 16, v37
    v_and_b32 v115, 0xffff0000, v37
    v_lshlrev_b32 v116, 16, v38
    v_and_b32 v117, 0xffff0000, v38
    v_lshlrev_b32 v118, 16, v39
    v_and_b32 v119, 0xffff0000, v39
    v_pk_add_f32 v[112:113], v[112:113], v[40:41]
    v_pk_add_f32 v[114:115], v[114:115], v[42:43]
    v_pk_add_f32 v[116:117], v[116:117], v[44:45]
    v_pk_add_f32 v[118:119], v[118:119], v[46:47]
    v_cvt_pk_bf16_f32 v36, v112, v113
    v_cvt_pk_bf16_f32 v37, v114, v115
    v_cvt_pk_bf16_f32 v38, v116, v117
    v_cvt_pk_bf16_f32 v39, v118, v119
    ds_write_b128 v7, v[36:39] offset:112
    s_waitcnt lgkmcnt(0)
    s_barrier
    ds_read_b128 v[8:11], v4 offset:0
    ds_read_b128 v[12:15], v4 offset:1056
    ds_read_b128 v[16:19], v4 offset:2112
    ds_read_b128 v[20:23], v4 offset:3168
    ds_read_b128 v[24:27], v4 offset:4224
    ds_read_b128 v[28:31], v4 offset:5280
    ds_read_b128 v[32:35], v4 offset:6336
    ds_read_b128 v[36:39], v4 offset:7392
    s_waitcnt vmcnt(31) lgkmcnt(7)
    v_mfma_f32_32x32x16_bf16 v[64:79], v[128:131], v[8:11], 0
    ds_read_b128 v[8:11], v4 offset:8448
    s_waitcnt vmcnt(30) lgkmcnt(7)
    v_mfma_f32_32x32x16_bf16 v[64:79], v[132:135], v[12:15], v[64:79]
    ds_read_b128 v[12:15], v4 offset:9504
    s_waitcnt vmcnt(29) lgkmcnt(7)
    v_mfma_f32_32x32x16_bf16 v[64:79], v[136:139], v[16:19], v[64:79]
    ds_read_b128 v[16:19], v4 offset:10560
    s_waitcnt vmcnt(28) lgkmcnt(7)
    v_mfma_f32_32x32x16_bf16 v[64:79], v[140:143], v[20:23], v[64:79]
    ds_read_b128 v[20:23], v4 offset:11616
    s_waitcnt vmcnt(27) lgkmcnt(7)
    v_mfma_f32_32x32x16_bf16 v[64:79], v[144:147], v[24:27], v[64:79]
    ds_read_b128 v[24:27], v4 offset:12672
    s_waitcnt vmcnt(26) lgkmcnt(7)
    v_mfma_f32_32x32x16_bf16 v[64:79], v[148:151], v[28:31], v[64:79]
    ds_read_b128 v[28:31], v4 offset:13728
    s_waitcnt vmcnt(25) lgkmcnt(7)
    v_mfma_f32_32x32x16_bf16 v[64:79], v[152:155], v[32:35], v[64:79]
    ds_read_b128 v[32:35], v4 offset:14784
    s_waitcnt vmcnt(24) lgkmcnt(7)
    v_mfma_f32_32x32x16_bf16 v[64:79], v[156:159], v[36:39], v[64:79]
    ds_read_b128 v[36:39], v4 offset:15840
    s_waitcnt vmcnt(23) lgkmcnt(7)
    v_mfma_f32_32x32x16_bf16 v[64:79], v[160:163], v[8:11], v[64:79]
    ds_read_b128 v[8:11], v4 offset:16896
    s_waitcnt vmcnt(22) lgkmcnt(7)
    v_mfma_f32_32x32x16_bf16 v[64:79], v[164:167], v[12:15], v[64:79]
    ds_read_b128 v[12:15], v4 offset:17952
    s_waitcnt vmcnt(21) lgkmcnt(7)
    v_mfma_f32_32x32x16_bf16 v[64:79], v[168:171], v[16:19], v[64:79]
    ds_read_b128 v[16:19], v4 offset:19008
    s_waitcnt vmcnt(20) lgkmcnt(7)
    v_mfma_f32_32x32x16_bf16 v[64:79], v[172:175], v[20:23], v[64:79]
    ds_read_b128 v[20:23], v4 offset:20064
    s_waitcnt vmcnt(19) lgkmcnt(7)
    v_mfma_f32_32x32x16_bf16 v[64:79], v[176:179], v[24:27], v[64:79]
    ds_read_b128 v[24:27], v4 offset:21120
    s_waitcnt vmcnt(18) lgkmcnt(7)
    v_mfma_f32_32x32x16_bf16 v[64:79], v[180:183], v[28:31], v[64:79]
    ds_read_b128 v[28:31], v4 offset:22176
    s_waitcnt vmcnt(17) lgkmcnt(7)
    v_mfma_f32_32x32x16_bf16 v[64:79], v[184:187], v[32:35], v[64:79]
    ds_read_b128 v[32:35], v4 offset:23232
    s_waitcnt vmcnt(16) lgkmcnt(7)
    v_mfma_f32_32x32x16_bf16 v[64:79], v[188:191], v[36:39], v[64:79]
    ds_read_b128 v[36:39], v4 offset:24288
    s_waitcnt vmcnt(15) lgkmcnt(7)
    v_mfma_f32_32x32x16_bf16 v[64:79], v[192:195], v[8:11], v[64:79]
    ds_read_b128 v[8:11], v4 offset:25344
    s_waitcnt vmcnt(14) lgkmcnt(7)
    v_mfma_f32_32x32x16_bf16 v[64:79], v[196:199], v[12:15], v[64:79]
    ds_read_b128 v[12:15], v4 offset:26400
    s_waitcnt vmcnt(13) lgkmcnt(7)
    v_mfma_f32_32x32x16_bf16 v[64:79], v[200:203], v[16:19], v[64:79]
    ds_read_b128 v[16:19], v4 offset:27456
    s_waitcnt vmcnt(12) lgkmcnt(7)
    v_mfma_f32_32x32x16_bf16 v[64:79], v[204:207], v[20:23], v[64:79]
    ds_read_b128 v[20:23], v4 offset:28512
    s_waitcnt vmcnt(11) lgkmcnt(7)
    v_mfma_f32_32x32x16_bf16 v[64:79], v[208:211], v[24:27], v[64:79]
    ds_read_b128 v[24:27], v4 offset:29568
    s_waitcnt vmcnt(10) lgkmcnt(7)
    v_mfma_f32_32x32x16_bf16 v[64:79], v[212:215], v[28:31], v[64:79]
    ds_read_b128 v[28:31], v4 offset:30624
    s_waitcnt vmcnt(9) lgkmcnt(7)
    v_mfma_f32_32x32x16_bf16 v[64:79], v[216:219], v[32:35], v[64:79]
    ds_read_b128 v[32:35], v4 offset:31680
    s_waitcnt vmcnt(8) lgkmcnt(7)
    v_mfma_f32_32x32x16_bf16 v[64:79], v[220:223], v[36:39], v[64:79]
    ds_read_b128 v[36:39], v4 offset:32736
    s_waitcnt vmcnt(7) lgkmcnt(7)
    v_mfma_f32_32x32x16_bf16 v[64:79], v[224:227], v[8:11], v[64:79]
    s_waitcnt vmcnt(6) lgkmcnt(6)
    v_mfma_f32_32x32x16_bf16 v[64:79], v[228:231], v[12:15], v[64:79]
    s_waitcnt vmcnt(5) lgkmcnt(5)
    v_mfma_f32_32x32x16_bf16 v[64:79], v[232:235], v[16:19], v[64:79]
    s_waitcnt vmcnt(4) lgkmcnt(4)
    v_mfma_f32_32x32x16_bf16 v[64:79], v[236:239], v[20:23], v[64:79]
    s_waitcnt vmcnt(3) lgkmcnt(3)
    v_mfma_f32_32x32x16_bf16 v[64:79], v[240:243], v[24:27], v[64:79]
    s_waitcnt vmcnt(2) lgkmcnt(2)
    v_mfma_f32_32x32x16_bf16 v[64:79], v[244:247], v[28:31], v[64:79]
    s_waitcnt vmcnt(1) lgkmcnt(1)
    v_mfma_f32_32x32x16_bf16 v[64:79], v[248:251], v[32:35], v[64:79]
    s_waitcnt vmcnt(0) lgkmcnt(0)
    v_mfma_f32_32x32x16_bf16 v[64:79], v[252:255], v[36:39], v[64:79]
    s_nop 15
    v_cvt_pk_bf16_f32 v8, v64, v65
    v_cvt_pk_bf16_f32 v9, v66, v67
    v_cvt_pk_bf16_f32 v10, v68, v69
    v_cvt_pk_bf16_f32 v11, v70, v71
    v_cvt_pk_bf16_f32 v12, v72, v73
    v_cvt_pk_bf16_f32 v13, v74, v75
    v_cvt_pk_bf16_f32 v14, v76, v77
    v_cvt_pk_bf16_f32 v15, v78, v79
    v_lshlrev_b32 v64, 16, v8
    v_and_b32 v65, 0xffff0000, v8
    v_lshlrev_b32 v66, 16, v9
    v_and_b32 v67, 0xffff0000, v9
    v_lshlrev_b32 v68, 16, v10
    v_and_b32 v69, 0xffff0000, v10
    v_lshlrev_b32 v70, 16, v11
    v_and_b32 v71, 0xffff0000, v11
    v_lshlrev_b32 v72, 16, v12
    v_and_b32 v73, 0xffff0000, v12
    v_lshlrev_b32 v74, 16, v13
    v_and_b32 v75, 0xffff0000, v13
    v_lshlrev_b32 v76, 16, v14
    v_and_b32 v77, 0xffff0000, v14
    v_lshlrev_b32 v78, 16, v15
    v_and_b32 v79, 0xffff0000, v15
    v_mul_f32 v64, 0x3eb8aa3b, v64
    v_mul_f32 v65, 0x3eb8aa3b, v65
    v_mul_f32 v66, 0x3eb8aa3b, v66
    v_mul_f32 v67, 0x3eb8aa3b, v67
    v_mul_f32 v68, 0x3eb8aa3b, v68
    v_mul_f32 v69, 0x3eb8aa3b, v69
    v_mul_f32 v70, 0x3eb8aa3b, v70
    v_mul_f32 v71, 0x3eb8aa3b, v71
    v_mul_f32 v72, 0x3eb8aa3b, v72
    v_mul_f32 v73, 0x3eb8aa3b, v73
    v_mul_f32 v74, 0x3eb8aa3b, v74
    v_mul_f32 v75, 0x3eb8aa3b, v75
    v_mul_f32 v76, 0x3eb8aa3b, v76
    v_mul_f32 v77, 0x3eb8aa3b, v77
    v_mul_f32 v78, 0x3eb8aa3b, v78
    v_mul_f32 v79, 0x3eb8aa3b, v79
    v_cvt_pk_bf16_f32 v8, v64, v65
    v_cvt_pk_bf16_f32 v9, v66, v67
    v_cvt_pk_bf16_f32 v10, v68, v69
    v_cvt_pk_bf16_f32 v11, v70, v71
    v_cvt_pk_bf16_f32 v12, v72, v73
    v_cvt_pk_bf16_f32 v13, v74, v75
    v_cvt_pk_bf16_f32 v14, v76, v77
    v_cvt_pk_bf16_f32 v15, v78, v79
    s_lshl_b32 s22, s20, 15
    s_lshl_b32 s23, s23, 11
    s_add_u32 s22, s22, s23
    s_add_u32 s22, s22, 0x320000
    buffer_store_dwordx4 v[8:11], v3, s[4:7], s22 offen sc0 sc1
    buffer_store_dwordx4 v[12:15], v3, s[4:7], s22 offen offset:1024 sc0 sc1
    s_endpgm
k1_kv:
    s_mov_b32 s38, 0x100
    s_mov_b32 s39, 0x00020000
    v_mov_b32 v9, 0
    v_mov_b32 v10, 0x20800
    ds_write_b32 v10, v9
    s_and_b32 s41, s2, 15
    s_lshr_b32 s40, s2, 5
    s_lshl_b32 s40, s40, 4
    s_add_u32 s41, s41, s40
    s_lshl_b32 s40, s41, 2
    s_add_u32 s40, s40, s3
    s_sub_u32 s40, s40, 4
    s_cmp_lt_u32 s21, 2
    s_cbranch_scc1 k1_wo
    s_cmp_lt_u32 s41, 96
    s_cbranch_scc1 k1_mod
    s_cmp_lt_u32 s41, 104
    s_cbranch_scc1 k1_wkv
    s_cmp_lg_u32 s3, 4
    s_cbranch_scc1 k1_end
    s_barrier
    s_cmp_lg_u32 s41, 104
    s_cbranch_scc1 k1_b1
    v_lshlrev_b32 v5, 7, v1
    v_mov_b32 v8, 0
    s_mov_b32 s24, 32768
    buffer_store_dword v8, v5, s[4:7], s24 offen sc0 sc1
    s_mov_b32 s24, 40960
    buffer_store_dword v8, v5, s[4:7], s24 offen sc0 sc1
    s_mov_b32 s24, 49152
    buffer_store_dword v8, v5, s[4:7], s24 offen sc0 sc1
    s_mov_b32 s24, 57344
    buffer_store_dword v8, v5, s[4:7], s24 offen sc0 sc1
    s_mov_b32 s24, 65536
    buffer_store_dword v8, v5, s[4:7], s24 offen sc0 sc1
    s_mov_b32 s24, 73728
    buffer_store_dword v8, v5, s[4:7], s24 offen sc0 sc1
    s_mov_b32 s24, 81920
    buffer_store_dword v8, v5, s[4:7], s24 offen sc0 sc1
    s_mov_b32 s24, 90112
    buffer_store_dword v8, v5, s[4:7], s24 offen sc0 sc1
    s_mov_b32 s24, 98304
    buffer_store_dword v8, v5, s[4:7], s24 offen sc0 sc1
k1_b1:
    s_barrier
k1_b2:
    s_mov_b32 s48, 200000
    v_and_b32 v10, 0, v1
    v_lshlrev_b32 v10, 2, v10
    v_add_u32 v10, 128, v10
    v_mov_b32 v9, 128
k1_pla:
    buffer_load_dword v11, v10, s[36:39], 0 offen sc0 sc1
    s_sub_u32 s48, s48, 1
    s_cmp_eq_u32 s48, 0
    s_cbranch_scc1 k1_pda
    s_waitcnt vmcnt(0)
    v_cmp_ne_u32 vcc, v9, v11
    s_cbranch_vccnz k1_pla
k1_pda:
    s_waitcnt vmcnt(0)
    s_barrier
    s_endpgm
k1_wkv:
    s_load_dwordx2 s[8:9], s[0:1], 16
    s_load_dwordx2 s[12:13], s[0:1], 24
    s_sub_u32 s40, s40, 384
    v_and_b32 v12, 15, v1
    v_bfe_u32 v13, v12, 2, 1
    v_lshlrev_b32 v13, 3, v13
    v_bfe_u32 v14, v12, 3, 1
    v_lshl_add_u32 v13, v14, 2, v13
    v_and_b32 v14, 3, v12
    v_add_u32 v13, v13, v14
    v_lshrrev_b32 v14, 5, v1
    v_lshlrev_b32 v14, 8, v14
    v_lshl_add_u32 v13, v13, 1, v14
    v_lshl_add_u32 v15, v12, 1, v14
    v_add_u32 v14, 128, v13
    v_add_u32 v12, 128, v15
    s_lshl_b32 s22, s40, 9
    v_lshlrev_b32 v3, 4, v1
    s_waitcnt lgkmcnt(0)
    s_mov_b32 s10, 0x4000
    s_mov_b32 s11, 0x00020000
    s_mov_b32 s14, 0x4000
    s_mov_b32 s15, 0x00020000
    buffer_load_ushort v16, v13, s[8:11], s22 offen offset:0
    buffer_load_ushort v17, v13, s[8:11], s22 offen offset:32
    buffer_load_ushort v18, v13, s[8:11], s22 offen offset:64
    buffer_load_ushort v19, v13, s[8:11], s22 offen offset:96
    buffer_load_ushort v20, v14, s[8:11], s22 offen offset:0
    buffer_load_ushort v21, v14, s[8:11], s22 offen offset:32
    buffer_load_ushort v22, v14, s[8:11], s22 offen offset:64
    buffer_load_ushort v23, v14, s[8:11], s22 offen offset:96
    buffer_load_ushort v24, v15, s[12:15], s22 offen offset:0
    buffer_load_ushort v25, v15, s[12:15], s22 offen offset:32
    buffer_load_ushort v26, v15, s[12:15], s22 offen offset:64
    buffer_load_ushort v27, v15, s[12:15], s22 offen offset:96
    buffer_load_ushort v28, v12, s[12:15], s22 offen offset:0
    buffer_load_ushort v29, v12, s[12:15], s22 offen offset:32
    buffer_load_ushort v30, v12, s[12:15], s22 offen offset:64
    buffer_load_ushort v31, v12, s[12:15], s22 offen offset:96
    s_lshl_b32 s24, s40, 10
    s_add_u32 s24, s24, 0x290000
    s_barrier
    v_and_b32 v2, 16, v1
    v_cmp_eq_u32 vcc, 0, v2
    s_nop 1
    s_waitcnt vmcnt(0)
    v_cndmask_b32 v16, v24, v16, vcc
    v_cndmask_b32 v17, v25, v17, vcc
    v_cndmask_b32 v18, v26, v18, vcc
    v_cndmask_b32 v19, v27, v19, vcc
    v_cndmask_b32 v20, v28, v20, vcc
    v_cndmask_b32 v21, v29, v21, vcc
    v_cndmask_b32 v22, v30, v22, vcc
    v_cndmask_b32 v23, v31, v23, vcc
    v_lshl_or_b32 v12, v17, 16, v16
    v_lshl_or_b32 v13, v19, 16, v18
    v_lshl_or_b32 v14, v21, 16, v20
    v_lshl_or_b32 v15, v23, 16, v22
    buffer_store_dwordx4 v[12:15], v3, s[4:7], s24 offen sc0 sc1
    v_mov_b32 v9, 1
    v_mov_b32 v10, 0x20800
    s_mov_b64 exec, 1
    s_waitcnt vmcnt(0)
    ds_add_rtn_u32 v11, v10, v9
    v_mov_b32 v12, 16
    v_mov_b32 v13, 0
    s_waitcnt lgkmcnt(0)
    v_readfirstlane_b32 s43, v11
    s_cmp_lg_u32 s43, 3
    s_cbranch_scc1 k1_nfw
    buffer_atomic_add v12, v13, s[36:39], 0 offen sc0 sc1
    v_mov_b32 v14, 128
    s_waitcnt vmcnt(0)
    v_readfirstlane_b32 s43, v12
    s_cmp_lg_u32 s43, 240
    s_cbranch_scc1 k1_nfw
    buffer_store_dword v14, v13, s[36:39], 0 offen offset:128 sc0 sc1
k1_nfw:
    s_mov_b64 exec, -1
    s_cmp_eq_u32 s3, 4
    s_cbranch_scc1 k1_b1
    s_endpgm
k1_mod:
    s_setprio 3
    v_bfe_u32 v2, v0, 2, 6
    v_and_b32 v3, 3, v0
    v_mul_u32_u24 v4, 6144, v2
    v_lshl_add_u32 v4, v3, 4, v4
    v_lshlrev_b32 v5, 1, v2
    s_lshl_b32 s42, s41, 6
    s_mov_b32 s46, 0x400
    s_mov_b32 s47, 0x00020000
    s_mov_b32 s54, 0x300000
    s_mov_b32 s55, 0x00020000
    buffer_load_ushort v8, v5, s[44:47], 0 offen offset:0
    buffer_load_ushort v9, v5, s[44:47], 0 offen offset:128
    buffer_load_ushort v10, v5, s[44:47], 0 offen offset:256
    buffer_load_ushort v11, v5, s[44:47], 0 offen offset:384
    buffer_load_ushort v12, v5, s[44:47], 0 offen offset:512
    buffer_load_ushort v13, v5, s[44:47], 0 offen offset:640
    buffer_load_ushort v14, v5, s[44:47], 0 offen offset:768
    buffer_load_ushort v15, v5, s[44:47], 0 offen offset:896
    buffer_load_dwordx4 v[16:19], v4, s[52:55], s42 offen
    s_add_u32 s42, s42, 393216
    buffer_load_dwordx4 v[20:23], v4, s[52:55], s42 offen
    s_add_u32 s42, s42, 393216
    buffer_load_dwordx4 v[24:27], v4, s[52:55], s42 offen
    s_add_u32 s42, s42, 393216
    buffer_load_dwordx4 v[28:31], v4, s[52:55], s42 offen
    s_add_u32 s42, s42, 393216
    buffer_load_dwordx4 v[32:35], v4, s[52:55], s42 offen
    s_add_u32 s42, s42, 393216
    buffer_load_dwordx4 v[36:39], v4, s[52:55], s42 offen
    s_add_u32 s42, s42, 393216
    buffer_load_dwordx4 v[40:43], v4, s[52:55], s42 offen
    s_add_u32 s42, s42, 393216
    buffer_load_dwordx4 v[44:47], v4, s[52:55], s42 offen
    s_add_u32 s42, s42, 393216
    s_waitcnt lgkmcnt(0)
    s_barrier
    s_waitcnt vmcnt(8)
    v_lshlrev_b32 v8, 16, v8
    v_mul_f32 v56, 0xbfb8aa3b, v8
    v_lshlrev_b32 v9, 16, v9
    v_mul_f32 v57, 0xbfb8aa3b, v9
    v_lshlrev_b32 v10, 16, v10
    v_mul_f32 v58, 0xbfb8aa3b, v10
    v_lshlrev_b32 v11, 16, v11
    v_mul_f32 v59, 0xbfb8aa3b, v11
    v_lshlrev_b32 v12, 16, v12
    v_mul_f32 v60, 0xbfb8aa3b, v12
    v_lshlrev_b32 v13, 16, v13
    v_mul_f32 v61, 0xbfb8aa3b, v13
    v_lshlrev_b32 v14, 16, v14
    v_mul_f32 v62, 0xbfb8aa3b, v14
    v_lshlrev_b32 v15, 16, v15
    v_mul_f32 v63, 0xbfb8aa3b, v15
    v_exp_f32 v56, v56
    v_exp_f32 v57, v57
    v_exp_f32 v58, v58
    v_exp_f32 v59, v59
    v_exp_f32 v60, v60
    v_exp_f32 v61, v61
    v_exp_f32 v62, v62
    v_exp_f32 v63, v63
    v_add_f32 v56, 1.0, v56
    v_add_f32 v57, 1.0, v57
    v_add_f32 v58, 1.0, v58
    v_add_f32 v59, 1.0, v59
    v_add_f32 v60, 1.0, v60
    v_add_f32 v61, 1.0, v61
    v_add_f32 v62, 1.0, v62
    v_add_f32 v63, 1.0, v63
    v_rcp_f32 v56, v56
    v_rcp_f32 v57, v57
    v_rcp_f32 v58, v58
    v_rcp_f32 v59, v59
    v_rcp_f32 v60, v60
    v_rcp_f32 v61, v61
    v_rcp_f32 v62, v62
    v_rcp_f32 v63, v63
    v_mul_f32 v8, v8, v56
    v_mul_f32 v9, v9, v57
    v_mul_f32 v10, v10, v58
    v_mul_f32 v11, v11, v59
    v_mul_f32 v12, v12, v60
    v_mul_f32 v13, v13, v61
    v_mul_f32 v14, v14, v62
    v_mul_f32 v15, v15, v63
    v_cvt_pk_bf16_f32 v8, v8, v8
    v_and_b32 v8, 0xffff0000, v8
    v_cvt_pk_bf16_f32 v9, v9, v9
    v_and_b32 v9, 0xffff0000, v9
    v_cvt_pk_bf16_f32 v10, v10, v10
    v_and_b32 v10, 0xffff0000, v10
    v_cvt_pk_bf16_f32 v11, v11, v11
    v_and_b32 v11, 0xffff0000, v11
    v_cvt_pk_bf16_f32 v12, v12, v12
    v_and_b32 v12, 0xffff0000, v12
    v_cvt_pk_bf16_f32 v13, v13, v13
    v_and_b32 v13, 0xffff0000, v13
    v_cvt_pk_bf16_f32 v14, v14, v14
    v_and_b32 v14, 0xffff0000, v14
    v_cvt_pk_bf16_f32 v15, v15, v15
    v_and_b32 v15, 0xffff0000, v15
    s_waitcnt vmcnt(7)
    v_lshlrev_b32 v56, 16, v16
    v_and_b32 v57, 0xffff0000, v16
    v_lshlrev_b32 v58, 16, v17
    v_and_b32 v59, 0xffff0000, v17
    v_lshlrev_b32 v60, 16, v18
    v_and_b32 v61, 0xffff0000, v18
    v_lshlrev_b32 v62, 16, v19
    v_and_b32 v63, 0xffff0000, v19
    v_mul_f32 v48, v8, v56
    v_mul_f32 v49, v8, v57
    v_mul_f32 v50, v8, v58
    v_mul_f32 v51, v8, v59
    v_mul_f32 v52, v8, v60
    v_mul_f32 v53, v8, v61
    v_mul_f32 v54, v8, v62
    v_mul_f32 v55, v8, v63
    s_waitcnt vmcnt(6)
    v_lshlrev_b32 v56, 16, v20
    v_and_b32 v57, 0xffff0000, v20
    v_lshlrev_b32 v58, 16, v21
    v_and_b32 v59, 0xffff0000, v21
    v_lshlrev_b32 v60, 16, v22
    v_and_b32 v61, 0xffff0000, v22
    v_lshlrev_b32 v62, 16, v23
    v_and_b32 v63, 0xffff0000, v23
    v_fmac_f32 v48, v9, v56
    v_fmac_f32 v49, v9, v57
    v_fmac_f32 v50, v9, v58
    v_fmac_f32 v51, v9, v59
    v_fmac_f32 v52, v9, v60
    v_fmac_f32 v53, v9, v61
    v_fmac_f32 v54, v9, v62
    v_fmac_f32 v55, v9, v63
    s_waitcnt vmcnt(5)
    v_lshlrev_b32 v56, 16, v24
    v_and_b32 v57, 0xffff0000, v24
    v_lshlrev_b32 v58, 16, v25
    v_and_b32 v59, 0xffff0000, v25
    v_lshlrev_b32 v60, 16, v26
    v_and_b32 v61, 0xffff0000, v26
    v_lshlrev_b32 v62, 16, v27
    v_and_b32 v63, 0xffff0000, v27
    v_fmac_f32 v48, v10, v56
    v_fmac_f32 v49, v10, v57
    v_fmac_f32 v50, v10, v58
    v_fmac_f32 v51, v10, v59
    v_fmac_f32 v52, v10, v60
    v_fmac_f32 v53, v10, v61
    v_fmac_f32 v54, v10, v62
    v_fmac_f32 v55, v10, v63
    s_waitcnt vmcnt(4)
    v_lshlrev_b32 v56, 16, v28
    v_and_b32 v57, 0xffff0000, v28
    v_lshlrev_b32 v58, 16, v29
    v_and_b32 v59, 0xffff0000, v29
    v_lshlrev_b32 v60, 16, v30
    v_and_b32 v61, 0xffff0000, v30
    v_lshlrev_b32 v62, 16, v31
    v_and_b32 v63, 0xffff0000, v31
    v_fmac_f32 v48, v11, v56
    v_fmac_f32 v49, v11, v57
    v_fmac_f32 v50, v11, v58
    v_fmac_f32 v51, v11, v59
    v_fmac_f32 v52, v11, v60
    v_fmac_f32 v53, v11, v61
    v_fmac_f32 v54, v11, v62
    v_fmac_f32 v55, v11, v63
    s_waitcnt vmcnt(3)
    v_lshlrev_b32 v56, 16, v32
    v_and_b32 v57, 0xffff0000, v32
    v_lshlrev_b32 v58, 16, v33
    v_and_b32 v59, 0xffff0000, v33
    v_lshlrev_b32 v60, 16, v34
    v_and_b32 v61, 0xffff0000, v34
    v_lshlrev_b32 v62, 16, v35
    v_and_b32 v63, 0xffff0000, v35
    v_fmac_f32 v48, v12, v56
    v_fmac_f32 v49, v12, v57
    v_fmac_f32 v50, v12, v58
    v_fmac_f32 v51, v12, v59
    v_fmac_f32 v52, v12, v60
    v_fmac_f32 v53, v12, v61
    v_fmac_f32 v54, v12, v62
    v_fmac_f32 v55, v12, v63
    s_waitcnt vmcnt(2)
    v_lshlrev_b32 v56, 16, v36
    v_and_b32 v57, 0xffff0000, v36
    v_lshlrev_b32 v58, 16, v37
    v_and_b32 v59, 0xffff0000, v37
    v_lshlrev_b32 v60, 16, v38
    v_and_b32 v61, 0xffff0000, v38
    v_lshlrev_b32 v62, 16, v39
    v_and_b32 v63, 0xffff0000, v39
    v_fmac_f32 v48, v13, v56
    v_fmac_f32 v49, v13, v57
    v_fmac_f32 v50, v13, v58
    v_fmac_f32 v51, v13, v59
    v_fmac_f32 v52, v13, v60
    v_fmac_f32 v53, v13, v61
    v_fmac_f32 v54, v13, v62
    v_fmac_f32 v55, v13, v63
    s_waitcnt vmcnt(1)
    v_lshlrev_b32 v56, 16, v40
    v_and_b32 v57, 0xffff0000, v40
    v_lshlrev_b32 v58, 16, v41
    v_and_b32 v59, 0xffff0000, v41
    v_lshlrev_b32 v60, 16, v42
    v_and_b32 v61, 0xffff0000, v42
    v_lshlrev_b32 v62, 16, v43
    v_and_b32 v63, 0xffff0000, v43
    v_fmac_f32 v48, v14, v56
    v_fmac_f32 v49, v14, v57
    v_fmac_f32 v50, v14, v58
    v_fmac_f32 v51, v14, v59
    v_fmac_f32 v52, v14, v60
    v_fmac_f32 v53, v14, v61
    v_fmac_f32 v54, v14, v62
    v_fmac_f32 v55, v14, v63
    s_waitcnt vmcnt(0)
    v_lshlrev_b32 v56, 16, v44
    v_and_b32 v57, 0xffff0000, v44
    v_lshlrev_b32 v58, 16, v45
    v_and_b32 v59, 0xffff0000, v45
    v_lshlrev_b32 v60, 16, v46
    v_and_b32 v61, 0xffff0000, v46
    v_lshlrev_b32 v62, 16, v47
    v_and_b32 v63, 0xffff0000, v47
    v_fmac_f32 v48, v15, v56
    v_fmac_f32 v49, v15, v57
    v_fmac_f32 v50, v15, v58
    v_fmac_f32 v51, v15, v59
    v_fmac_f32 v52, v15, v60
    v_fmac_f32 v53, v15, v61
    v_fmac_f32 v54, v15, v62
    v_fmac_f32 v55, v15, v63
    v_add_f32_dpp v48, v48, v48 row_ror:4 row_mask:0xf bank_mask:0xf
    v_add_f32_dpp v49, v49, v49 row_ror:4 row_mask:0xf bank_mask:0xf
    v_add_f32_dpp v50, v50, v50 row_ror:4 row_mask:0xf bank_mask:0xf
    v_add_f32_dpp v51, v51, v51 row_ror:4 row_mask:0xf bank_mask:0xf
    v_add_f32_dpp v52, v52, v52 row_ror:4 row_mask:0xf bank_mask:0xf
    v_add_f32_dpp v53, v53, v53 row_ror:4 row_mask:0xf bank_mask:0xf
    v_add_f32_dpp v54, v54, v54 row_ror:4 row_mask:0xf bank_mask:0xf
    v_add_f32_dpp v55, v55, v55 row_ror:4 row_mask:0xf bank_mask:0xf
    v_add_f32_dpp v48, v48, v48 row_ror:8 row_mask:0xf bank_mask:0xf
    v_add_f32_dpp v49, v49, v49 row_ror:8 row_mask:0xf bank_mask:0xf
    v_add_f32_dpp v50, v50, v50 row_ror:8 row_mask:0xf bank_mask:0xf
    v_add_f32_dpp v51, v51, v51 row_ror:8 row_mask:0xf bank_mask:0xf
    v_add_f32_dpp v52, v52, v52 row_ror:8 row_mask:0xf bank_mask:0xf
    v_add_f32_dpp v53, v53, v53 row_ror:8 row_mask:0xf bank_mask:0xf
    v_add_f32_dpp v54, v54, v54 row_ror:8 row_mask:0xf bank_mask:0xf
    v_add_f32_dpp v55, v55, v55 row_ror:8 row_mask:0xf bank_mask:0xf
    v_bfe_u32 v2, v0, 4, 4
    v_lshlrev_b32 v2, 7, v2
    v_lshl_add_u32 v2, v3, 5, v2
    v_add_u32 v2, 0x20000, v2
    ds_write_b128 v2, v[48:51]
    ds_write_b128 v2, v[52:55] offset:16
    v_mov_b32 v9, 1
    v_mov_b32 v10, 0x20800
    v_and_b32 v2, 31, v0
    v_lshlrev_b32 v2, 2, v2
    v_add_u32 v6, 0x20000, v2
    s_waitcnt lgkmcnt(0)
    s_mov_b64 exec, 1
    ds_add_rtn_u32 v11, v10, v9
    s_waitcnt lgkmcnt(0)
    v_readfirstlane_b32 s43, v11
    s_mov_b64 exec, -1
    s_cmp_lg_u32 s43, 3
    s_cbranch_scc1 k1_jd
    ds_read_b32 v8, v6 offset:0
    ds_read_b32 v9, v6 offset:128
    ds_read_b32 v10, v6 offset:256
    ds_read_b32 v11, v6 offset:384
    ds_read_b32 v12, v6 offset:512
    ds_read_b32 v13, v6 offset:640
    ds_read_b32 v14, v6 offset:768
    ds_read_b32 v15, v6 offset:896
    ds_read_b32 v16, v6 offset:1024
    ds_read_b32 v17, v6 offset:1152
    ds_read_b32 v18, v6 offset:1280
    ds_read_b32 v19, v6 offset:1408
    ds_read_b32 v20, v6 offset:1536
    ds_read_b32 v21, v6 offset:1664
    ds_read_b32 v22, v6 offset:1792
    ds_read_b32 v23, v6 offset:1920
    s_waitcnt lgkmcnt(0)
    v_add_f32 v8, v8, v16
    v_add_f32 v9, v9, v17
    v_add_f32 v10, v10, v18
    v_add_f32 v11, v11, v19
    v_add_f32 v12, v12, v20
    v_add_f32 v13, v13, v21
    v_add_f32 v14, v14, v22
    v_add_f32 v15, v15, v23
    v_add_f32 v8, v8, v12
    v_add_f32 v9, v9, v13
    v_add_f32 v10, v10, v14
    v_add_f32 v11, v11, v15
    v_add_f32 v8, v8, v10
    v_add_f32 v9, v9, v11
    v_add_f32 v8, v8, v9
    v_cvt_pk_bf16_f32 v8, v8, v8
    v_and_b32 v8, 0xffff0000, v8
    s_lshr_b32 s43, s41, 4
    s_cmp_eq_u32 s43, 1
    s_cselect_b32 s42, 1.0, 0
    s_cmp_eq_u32 s43, 4
    s_cselect_b32 s42, 1.0, s42
    v_add_f32 v8, s42, v8
    v_cvt_pk_bf16_f32 v8, v8, v8
    v_and_b32 v8, 0xffff0000, v8
    s_lshl_b32 s42, s41, 7
    buffer_store_dword v8, v2, s[4:7], s42 offen sc0 sc1
    s_cmp_ge_u32 s41, 32
    s_cbranch_scc1 k1_jd
    v_mov_b32 v12, 4
    v_mov_b32 v13, 0
    s_and_b32 s49, s41, 0
    s_mov_b32 s50, 252
    s_cselect_b32 s50, 124, s50
    s_lshl_b32 s51, s49, 2
    s_mul_i32 s49, s49, 64
    s_waitcnt vmcnt(0)
    s_mov_b64 exec, 1
    buffer_atomic_add v12, v13, s[36:39], s49 offen sc0 sc1
    v_mov_b32 v14, 128
    s_waitcnt vmcnt(0)
    v_readfirstlane_b32 s43, v12
    s_cmp_lg_u32 s43, s50
    s_cbranch_scc1 k1_nm
    buffer_store_dword v14, v13, s[36:39], s51 offen offset:128 sc0 sc1
k1_nm:
    s_mov_b64 exec, -1
k1_jd:
    s_cmp_eq_u32 s3, 4
    s_cbranch_scc1 k1_b1
    s_endpgm
k1_wo:
    s_load_dwordx2 s[16:17], s[0:1], 32
    s_waitcnt lgkmcnt(0)
    s_mov_b32 s18, 0x80000
    s_mov_b32 s19, 0x00020000
    v_and_b32 v12, 15, v1
    v_lshrrev_b32 v13, 2, v12
    v_lshlrev_b32 v13, 4, v13
    v_and_b32 v14, 3, v12
    v_add_u32 v13, v13, v14
    v_lshrrev_b32 v14, 4, v1
    v_lshlrev_b32 v14, 14, v14
    v_lshl_add_u32 v13, v13, 1, v14
    v_add_u32 v14, 8192, v13
    s_and_b32 s22, s40, 7
    s_lshl_b32 s22, s22, 16
    s_bfe_u32 s23, s40, 0x10003
    s_lshl_b32 s23, s23, 12
    s_add_u32 s22, s22, s23
    s_lshr_b32 s23, s40, 6
    s_lshl_b32 s23, s23, 7
    s_add_u32 s22, s22, s23
    s_bfe_u32 s23, s40, 0x20004
    s_lshl_b32 s23, s23, 3
    s_add_u32 s22, s22, s23
    buffer_load_ushort v16, v13, s[16:19], s22 offen offset:0
    buffer_load_ushort v17, v13, s[16:19], s22 offen offset:1024
    buffer_load_ushort v18, v13, s[16:19], s22 offen offset:2048
    buffer_load_ushort v19, v13, s[16:19], s22 offen offset:3072
    buffer_load_ushort v20, v14, s[16:19], s22 offen offset:0
    buffer_load_ushort v21, v14, s[16:19], s22 offen offset:1024
    buffer_load_ushort v22, v14, s[16:19], s22 offen offset:2048
    buffer_load_ushort v23, v14, s[16:19], s22 offen offset:3072
    s_lshl_b32 s24, s40, 10
    s_add_u32 s24, s24, 0x2a0000
    s_barrier
    s_waitcnt vmcnt(0)
    v_lshl_or_b32 v12, v17, 16, v16
    v_lshl_or_b32 v13, v19, 16, v18
    v_lshl_or_b32 v14, v21, 16, v20
    v_lshl_or_b32 v15, v23, 16, v22
    buffer_store_dwordx4 v[12:15], v3, s[4:7], s24 offen sc0 sc1
    s_cmp_lg_u32 s3, 4
    s_cbranch_scc1 k1_end
    s_barrier
    s_mov_b32 s48, 200000
    v_and_b32 v10, 0, v1
    v_lshlrev_b32 v10, 2, v10
    v_add_u32 v10, 128, v10
    v_mov_b32 v9, 128
k1_plb:
    buffer_load_dword v11, v10, s[36:39], 0 offen sc0 sc1
    s_sub_u32 s48, s48, 1
    s_cmp_eq_u32 s48, 0
    s_cbranch_scc1 k1_pdb
    s_waitcnt vmcnt(0)
    v_cmp_ne_u32 vcc, v9, v11
    s_cbranch_vccnz k1_plb
k1_pdb:
    s_waitcnt vmcnt(0)
    s_barrier
    s_mov_b32 s24, 0x290000
    buffer_load_dwordx4 v[128:131], v3, s[4:7], s24 offen offset:0
    buffer_load_dwordx4 v[132:135], v3, s[4:7], s24 offen offset:1024
    buffer_load_dwordx4 v[136:139], v3, s[4:7], s24 offen offset:2048
    buffer_load_dwordx4 v[140:143], v3, s[4:7], s24 offen offset:3072
    s_add_u32 s24, s24, 4096
    buffer_load_dwordx4 v[144:147], v3, s[4:7], s24 offen offset:0
    buffer_load_dwordx4 v[148:151], v3, s[4:7], s24 offen offset:1024
    buffer_load_dwordx4 v[152:155], v3, s[4:7], s24 offen offset:2048
    buffer_load_dwordx4 v[156:159], v3, s[4:7], s24 offen offset:3072
    s_add_u32 s24, s24, 4096
    buffer_load_dwordx4 v[160:163], v3, s[4:7], s24 offen offset:0
    buffer_load_dwordx4 v[164:167], v3, s[4:7], s24 offen offset:1024
    buffer_load_dwordx4 v[168:171], v3, s[4:7], s24 offen offset:2048
    buffer_load_dwordx4 v[172:175], v3, s[4:7], s24 offen offset:3072
    s_add_u32 s24, s24, 4096
    buffer_load_dwordx4 v[176:179], v3, s[4:7], s24 offen offset:0
    buffer_load_dwordx4 v[180:183], v3, s[4:7], s24 offen offset:1024
    buffer_load_dwordx4 v[184:187], v3, s[4:7], s24 offen offset:2048
    buffer_load_dwordx4 v[188:191], v3, s[4:7], s24 offen offset:3072
    s_add_u32 s24, s24, 4096
    buffer_load_dwordx4 v[192:195], v3, s[4:7], s24 offen offset:0
    buffer_load_dwordx4 v[196:199], v3, s[4:7], s24 offen offset:1024
    buffer_load_dwordx4 v[200:203], v3, s[4:7], s24 offen offset:2048
    buffer_load_dwordx4 v[204:207], v3, s[4:7], s24 offen offset:3072
    s_add_u32 s24, s24, 4096
    buffer_load_dwordx4 v[208:211], v3, s[4:7], s24 offen offset:0
    buffer_load_dwordx4 v[212:215], v3, s[4:7], s24 offen offset:1024
    buffer_load_dwordx4 v[216:219], v3, s[4:7], s24 offen offset:2048
    buffer_load_dwordx4 v[220:223], v3, s[4:7], s24 offen offset:3072
    s_add_u32 s24, s24, 4096
    buffer_load_dwordx4 v[224:227], v3, s[4:7], s24 offen offset:0
    buffer_load_dwordx4 v[228:231], v3, s[4:7], s24 offen offset:1024
    buffer_load_dwordx4 v[232:235], v3, s[4:7], s24 offen offset:2048
    buffer_load_dwordx4 v[236:239], v3, s[4:7], s24 offen offset:3072
    s_add_u32 s24, s24, 4096
    buffer_load_dwordx4 v[240:243], v3, s[4:7], s24 offen offset:0
    buffer_load_dwordx4 v[244:247], v3, s[4:7], s24 offen offset:1024
    buffer_load_dwordx4 v[248:251], v3, s[4:7], s24 offen offset:2048
    buffer_load_dwordx4 v[252:255], v3, s[4:7], s24 offen offset:3072
    s_mul_i32 s22, s20, 2112
    s_add_u32 s22, s22, 0x520000
    s_cmp_eq_u32 s21, 1
    s_cbranch_scc1 k1_v
    s_waitcnt lgkmcnt(0)
    s_barrier
    ds_read_b128 v[8:11], v4 offset:0
    ds_read_b128 v[12:15], v4 offset:1056
    ds_read_b128 v[16:19], v4 offset:2112
    ds_read_b128 v[20:23], v4 offset:3168
    ds_read_b128 v[24:27], v4 offset:4224
    ds_read_b128 v[28:31], v4 offset:5280
    ds_read_b128 v[32:35], v4 offset:6336
    ds_read_b128 v[36:39], v4 offset:7392
    s_waitcnt vmcnt(31) lgkmcnt(7)
    v_mfma_f32_32x32x16_bf16 v[64:79], v[128:131], v[8:11], 0
    ds_read_b128 v[8:11], v4 offset:8448
    s_waitcnt vmcnt(30) lgkmcnt(7)
    v_mfma_f32_32x32x16_bf16 v[64:79], v[132:135], v[12:15], v[64:79]
    ds_read_b128 v[12:15], v4 offset:9504
    s_waitcnt vmcnt(29) lgkmcnt(7)
    v_mfma_f32_32x32x16_bf16 v[64:79], v[136:139], v[16:19], v[64:79]
    ds_read_b128 v[16:19], v4 offset:10560
    s_waitcnt vmcnt(28) lgkmcnt(7)
    v_mfma_f32_32x32x16_bf16 v[64:79], v[140:143], v[20:23], v[64:79]
    ds_read_b128 v[20:23], v4 offset:11616
    s_waitcnt vmcnt(27) lgkmcnt(7)
    v_mfma_f32_32x32x16_bf16 v[64:79], v[144:147], v[24:27], v[64:79]
    ds_read_b128 v[24:27], v4 offset:12672
    s_waitcnt vmcnt(26) lgkmcnt(7)
    v_mfma_f32_32x32x16_bf16 v[64:79], v[148:151], v[28:31], v[64:79]
    ds_read_b128 v[28:31], v4 offset:13728
    s_waitcnt vmcnt(25) lgkmcnt(7)
    v_mfma_f32_32x32x16_bf16 v[64:79], v[152:155], v[32:35], v[64:79]
    ds_read_b128 v[32:35], v4 offset:14784
    s_waitcnt vmcnt(24) lgkmcnt(7)
    v_mfma_f32_32x32x16_bf16 v[64:79], v[156:159], v[36:39], v[64:79]
    ds_read_b128 v[36:39], v4 offset:15840
    s_waitcnt vmcnt(23) lgkmcnt(7)
    v_mfma_f32_32x32x16_bf16 v[64:79], v[160:163], v[8:11], v[64:79]
    ds_read_b128 v[8:11], v4 offset:16896
    s_waitcnt vmcnt(22) lgkmcnt(7)
    v_mfma_f32_32x32x16_bf16 v[64:79], v[164:167], v[12:15], v[64:79]
    ds_read_b128 v[12:15], v4 offset:17952
    s_waitcnt vmcnt(21) lgkmcnt(7)
    v_mfma_f32_32x32x16_bf16 v[64:79], v[168:171], v[16:19], v[64:79]
    ds_read_b128 v[16:19], v4 offset:19008
    s_waitcnt vmcnt(20) lgkmcnt(7)
    v_mfma_f32_32x32x16_bf16 v[64:79], v[172:175], v[20:23], v[64:79]
    ds_read_b128 v[20:23], v4 offset:20064
    s_waitcnt vmcnt(19) lgkmcnt(7)
    v_mfma_f32_32x32x16_bf16 v[64:79], v[176:179], v[24:27], v[64:79]
    ds_read_b128 v[24:27], v4 offset:21120
    s_waitcnt vmcnt(18) lgkmcnt(7)
    v_mfma_f32_32x32x16_bf16 v[64:79], v[180:183], v[28:31], v[64:79]
    ds_read_b128 v[28:31], v4 offset:22176
    s_waitcnt vmcnt(17) lgkmcnt(7)
    v_mfma_f32_32x32x16_bf16 v[64:79], v[184:187], v[32:35], v[64:79]
    ds_read_b128 v[32:35], v4 offset:23232
    s_waitcnt vmcnt(16) lgkmcnt(7)
    v_mfma_f32_32x32x16_bf16 v[64:79], v[188:191], v[36:39], v[64:79]
    ds_read_b128 v[36:39], v4 offset:24288
    s_waitcnt vmcnt(15) lgkmcnt(7)
    v_mfma_f32_32x32x16_bf16 v[64:79], v[192:195], v[8:11], v[64:79]
    ds_read_b128 v[8:11], v4 offset:25344
    s_waitcnt vmcnt(14) lgkmcnt(7)
    v_mfma_f32_32x32x16_bf16 v[64:79], v[196:199], v[12:15], v[64:79]
    ds_read_b128 v[12:15], v4 offset:26400
    s_waitcnt vmcnt(13) lgkmcnt(7)
    v_mfma_f32_32x32x16_bf16 v[64:79], v[200:203], v[16:19], v[64:79]
    ds_read_b128 v[16:19], v4 offset:27456
    s_waitcnt vmcnt(12) lgkmcnt(7)
    v_mfma_f32_32x32x16_bf16 v[64:79], v[204:207], v[20:23], v[64:79]
    ds_read_b128 v[20:23], v4 offset:28512
    s_waitcnt vmcnt(11) lgkmcnt(7)
    v_mfma_f32_32x32x16_bf16 v[64:79], v[208:211], v[24:27], v[64:79]
    ds_read_b128 v[24:27], v4 offset:29568
    s_waitcnt vmcnt(10) lgkmcnt(7)
    v_mfma_f32_32x32x16_bf16 v[64:79], v[212:215], v[28:31], v[64:79]
    ds_read_b128 v[28:31], v4 offset:30624
    s_waitcnt vmcnt(9) lgkmcnt(7)
    v_mfma_f32_32x32x16_bf16 v[64:79], v[216:219], v[32:35], v[64:79]
    ds_read_b128 v[32:35], v4 offset:31680
    s_waitcnt vmcnt(8) lgkmcnt(7)
    v_mfma_f32_32x32x16_bf16 v[64:79], v[220:223], v[36:39], v[64:79]
    ds_read_b128 v[36:39], v4 offset:32736
    s_waitcnt vmcnt(7) lgkmcnt(7)
    v_mfma_f32_32x32x16_bf16 v[64:79], v[224:227], v[8:11], v[64:79]
    s_waitcnt vmcnt(6) lgkmcnt(6)
    v_mfma_f32_32x32x16_bf16 v[64:79], v[228:231], v[12:15], v[64:79]
    s_waitcnt vmcnt(5) lgkmcnt(5)
    v_mfma_f32_32x32x16_bf16 v[64:79], v[232:235], v[16:19], v[64:79]
    s_waitcnt vmcnt(4) lgkmcnt(4)
    v_mfma_f32_32x32x16_bf16 v[64:79], v[236:239], v[20:23], v[64:79]
    s_waitcnt vmcnt(3) lgkmcnt(3)
    v_mfma_f32_32x32x16_bf16 v[64:79], v[240:243], v[24:27], v[64:79]
    s_waitcnt vmcnt(2) lgkmcnt(2)
    v_mfma_f32_32x32x16_bf16 v[64:79], v[244:247], v[28:31], v[64:79]
    s_waitcnt vmcnt(1) lgkmcnt(1)
    v_mfma_f32_32x32x16_bf16 v[64:79], v[248:251], v[32:35], v[64:79]
    s_waitcnt vmcnt(0) lgkmcnt(0)
    v_mfma_f32_32x32x16_bf16 v[64:79], v[252:255], v[36:39], v[64:79]
    s_nop 15
    v_cvt_pk_bf16_f32 v8, v64, v65
    v_cvt_pk_bf16_f32 v9, v66, v67
    v_cvt_pk_bf16_f32 v10, v68, v69
    v_cvt_pk_bf16_f32 v11, v70, v71
    buffer_store_dwordx4 v[8:11], v3, s[4:7], s22 offen sc0 sc1
    s_endpgm
k1_v:
    s_waitcnt lgkmcnt(0)
    s_barrier
    ds_read_b128 v[8:11], v4 offset:0
    ds_read_b128 v[12:15], v4 offset:1056
    ds_read_b128 v[16:19], v4 offset:2112
    ds_read_b128 v[20:23], v4 offset:3168
    ds_read_b128 v[24:27], v4 offset:4224
    ds_read_b128 v[28:31], v4 offset:5280
    ds_read_b128 v[32:35], v4 offset:6336
    ds_read_b128 v[36:39], v4 offset:7392
    s_waitcnt vmcnt(31) lgkmcnt(7)
    v_mfma_f32_32x32x16_bf16 v[64:79], v[8:11], v[128:131], 0
    ds_read_b128 v[8:11], v4 offset:8448
    s_waitcnt vmcnt(30) lgkmcnt(7)
    v_mfma_f32_32x32x16_bf16 v[64:79], v[12:15], v[132:135], v[64:79]
    ds_read_b128 v[12:15], v4 offset:9504
    s_waitcnt vmcnt(29) lgkmcnt(7)
    v_mfma_f32_32x32x16_bf16 v[64:79], v[16:19], v[136:139], v[64:79]
    ds_read_b128 v[16:19], v4 offset:10560
    s_waitcnt vmcnt(28) lgkmcnt(7)
    v_mfma_f32_32x32x16_bf16 v[64:79], v[20:23], v[140:143], v[64:79]
    ds_read_b128 v[20:23], v4 offset:11616
    s_waitcnt vmcnt(27) lgkmcnt(7)
    v_mfma_f32_32x32x16_bf16 v[64:79], v[24:27], v[144:147], v[64:79]
    ds_read_b128 v[24:27], v4 offset:12672
    s_waitcnt vmcnt(26) lgkmcnt(7)
    v_mfma_f32_32x32x16_bf16 v[64:79], v[28:31], v[148:151], v[64:79]
    ds_read_b128 v[28:31], v4 offset:13728
    s_waitcnt vmcnt(25) lgkmcnt(7)
    v_mfma_f32_32x32x16_bf16 v[64:79], v[32:35], v[152:155], v[64:79]
    ds_read_b128 v[32:35], v4 offset:14784
    s_waitcnt vmcnt(24) lgkmcnt(7)
    v_mfma_f32_32x32x16_bf16 v[64:79], v[36:39], v[156:159], v[64:79]
    ds_read_b128 v[36:39], v4 offset:15840
    s_waitcnt vmcnt(23) lgkmcnt(7)
    v_mfma_f32_32x32x16_bf16 v[64:79], v[8:11], v[160:163], v[64:79]
    ds_read_b128 v[8:11], v4 offset:16896
    s_waitcnt vmcnt(22) lgkmcnt(7)
    v_mfma_f32_32x32x16_bf16 v[64:79], v[12:15], v[164:167], v[64:79]
    ds_read_b128 v[12:15], v4 offset:17952
    s_waitcnt vmcnt(21) lgkmcnt(7)
    v_mfma_f32_32x32x16_bf16 v[64:79], v[16:19], v[168:171], v[64:79]
    ds_read_b128 v[16:19], v4 offset:19008
    s_waitcnt vmcnt(20) lgkmcnt(7)
    v_mfma_f32_32x32x16_bf16 v[64:79], v[20:23], v[172:175], v[64:79]
    ds_read_b128 v[20:23], v4 offset:20064
    s_waitcnt vmcnt(19) lgkmcnt(7)
    v_mfma_f32_32x32x16_bf16 v[64:79], v[24:27], v[176:179], v[64:79]
    ds_read_b128 v[24:27], v4 offset:21120
    s_waitcnt vmcnt(18) lgkmcnt(7)
    v_mfma_f32_32x32x16_bf16 v[64:79], v[28:31], v[180:183], v[64:79]
    ds_read_b128 v[28:31], v4 offset:22176
    s_waitcnt vmcnt(17) lgkmcnt(7)
    v_mfma_f32_32x32x16_bf16 v[64:79], v[32:35], v[184:187], v[64:79]
    ds_read_b128 v[32:35], v4 offset:23232
    s_waitcnt vmcnt(16) lgkmcnt(7)
    v_mfma_f32_32x32x16_bf16 v[64:79], v[36:39], v[188:191], v[64:79]
    ds_read_b128 v[36:39], v4 offset:24288
    s_waitcnt vmcnt(15) lgkmcnt(7)
    v_mfma_f32_32x32x16_bf16 v[64:79], v[8:11], v[192:195], v[64:79]
    ds_read_b128 v[8:11], v4 offset:25344
    s_waitcnt vmcnt(14) lgkmcnt(7)
    v_mfma_f32_32x32x16_bf16 v[64:79], v[12:15], v[196:199], v[64:79]
    ds_read_b128 v[12:15], v4 offset:26400
    s_waitcnt vmcnt(13) lgkmcnt(7)
    v_mfma_f32_32x32x16_bf16 v[64:79], v[16:19], v[200:203], v[64:79]
    ds_read_b128 v[16:19], v4 offset:27456
    s_waitcnt vmcnt(12) lgkmcnt(7)
    v_mfma_f32_32x32x16_bf16 v[64:79], v[20:23], v[204:207], v[64:79]
    ds_read_b128 v[20:23], v4 offset:28512
    s_waitcnt vmcnt(11) lgkmcnt(7)
    v_mfma_f32_32x32x16_bf16 v[64:79], v[24:27], v[208:211], v[64:79]
    ds_read_b128 v[24:27], v4 offset:29568
    s_waitcnt vmcnt(10) lgkmcnt(7)
    v_mfma_f32_32x32x16_bf16 v[64:79], v[28:31], v[212:215], v[64:79]
    ds_read_b128 v[28:31], v4 offset:30624
    s_waitcnt vmcnt(9) lgkmcnt(7)
    v_mfma_f32_32x32x16_bf16 v[64:79], v[32:35], v[216:219], v[64:79]
    ds_read_b128 v[32:35], v4 offset:31680
    s_waitcnt vmcnt(8) lgkmcnt(7)
    v_mfma_f32_32x32x16_bf16 v[64:79], v[36:39], v[220:223], v[64:79]
    ds_read_b128 v[36:39], v4 offset:32736
    s_waitcnt vmcnt(7) lgkmcnt(7)
    v_mfma_f32_32x32x16_bf16 v[64:79], v[8:11], v[224:227], v[64:79]
    s_waitcnt vmcnt(6) lgkmcnt(6)
    v_mfma_f32_32x32x16_bf16 v[64:79], v[12:15], v[228:231], v[64:79]
    s_waitcnt vmcnt(5) lgkmcnt(5)
    v_mfma_f32_32x32x16_bf16 v[64:79], v[16:19], v[232:235], v[64:79]
    s_waitcnt vmcnt(4) lgkmcnt(4)
    v_mfma_f32_32x32x16_bf16 v[64:79], v[20:23], v[236:239], v[64:79]
    s_waitcnt vmcnt(3) lgkmcnt(3)
    v_mfma_f32_32x32x16_bf16 v[64:79], v[24:27], v[240:243], v[64:79]
    s_waitcnt vmcnt(2) lgkmcnt(2)
    v_mfma_f32_32x32x16_bf16 v[64:79], v[28:31], v[244:247], v[64:79]
    s_waitcnt vmcnt(1) lgkmcnt(1)
    v_mfma_f32_32x32x16_bf16 v[64:79], v[32:35], v[248:251], v[64:79]
    s_waitcnt vmcnt(0) lgkmcnt(0)
    v_mfma_f32_32x32x16_bf16 v[64:79], v[36:39], v[252:255], v[64:79]
    s_nop 15
    v_cvt_pk_bf16_f32 v8, v64, v65
    v_cvt_pk_bf16_f32 v9, v66, v67
    v_cvt_pk_bf16_f32 v10, v68, v69
    v_cvt_pk_bf16_f32 v11, v70, v71
    v_cvt_pk_bf16_f32 v12, v72, v73
    v_cvt_pk_bf16_f32 v13, v74, v75
    v_cvt_pk_bf16_f32 v14, v76, v77
    v_cvt_pk_bf16_f32 v15, v78, v79
    v_and_b32 v5, 15, v1
    v_and_b32 v6, 16, v1
    v_cmp_ne_u32 vcc, 0, v6
    v_lshrrev_b32 v6, 5, v1
    v_add_u32 v7, -1, v6
    v_and_b32 v7, 0x3f803f80, v7
    v_mul_u32_u24 v6, 272, v6
    v_cndmask_b32 v5, 16, v5, vcc
    v_lshl_add_u32 v5, v5, 4, v6
    v_cndmask_b32 v8, v7, v8, vcc
    v_cndmask_b32 v9, v7, v9, vcc
    v_cndmask_b32 v10, v7, v10, vcc
    v_cndmask_b32 v11, v7, v11, vcc
    v_cndmask_b32 v12, v7, v12, vcc
    v_cndmask_b32 v13, v7, v13, vcc
    v_cndmask_b32 v14, v7, v14, vcc
    v_cndmask_b32 v15, v7, v15, vcc
    buffer_store_dwordx4 v[8:11], v5, s[4:7], s22 offen offset:1024 sc0 sc1
    buffer_store_dwordx4 v[12:15], v5, s[4:7], s22 offen offset:1568 sc0 sc1
k1_end:
    s_endpgm
.globl k2_kernel
.p2align 8
.type k2_kernel,@function
k2_kernel:
    s_cmp_ge_u32 s2, 256
    s_cbranch_scc1 k2_end
    s_load_dwordx2 s[4:5], s[0:1], 104
    s_load_dwordx2 s[8:9], s[0:1], 0
    s_load_dwordx2 s[16:17], s[0:1], 48
    s_load_dwordx2 s[18:19], s[0:1], 56
    s_load_dwordx2 s[20:21], s[0:1], 64
    v_and_b32 v1, 63, v0
    v_lshrrev_b32 v2, 6, v0
    s_nop 0
    v_readfirstlane_b32 s3, v2
    s_lshl_b32 s24, s2, 3
    s_add_u32 s24, s24, s3
    v_lshlrev_b32 v3, 4, v1
    v_and_b32 v2, 31, v1
    v_lshrrev_b32 v94, 1, v2
    v_lshlrev_b32 v94, 11, v94
    v_and_b32 v92, 1, v2
    v_lshl_add_u32 v94, v92, 9, v94
    v_lshrrev_b32 v92, 5, v1
    v_lshl_add_u32 v94, v92, 10, v94
    s_lshr_b32 s25, s24, 5
    s_lshl_b32 s25, s25, 15
    s_and_b32 s26, s24, 31
    s_lshl_b32 s26, s26, 4
    s_add_u32 s25, s25, s26
    s_add_u32 s26, s25, 0x320000
    s_lshl_b32 s27, s3, 10
    s_add_u32 s28, s27, 0x520000
    s_mov_b32 m0, s27
    s_waitcnt lgkmcnt(0)
    s_mov_b32 s6, 0x1590000
    s_mov_b32 s7, 0x00020000
    s_mov_b32 s10, 0x200000
    s_mov_b32 s11, 0x00020000
    buffer_load_dwordx4 v3, s[4:7], s28 offen lds
    s_add_u32 m0, s27, 8192
    s_add_u32 s28, s28, 8192
    buffer_load_dwordx4 v3, s[4:7], s28 offen lds
    buffer_load_dwordx4 v[4:7], v94, s[4:7], s26 offen
    v_cmp_lt_u32 vcc, 16, v2
    v_cmp_eq_u32 s[30:31], 16, v2
    v_min_u32 v2, 16, v2
    v_cndmask_b32 v92, v92, 1, vcc
    v_cndmask_b32 v92, v92, 0, s[30:31]
    v_mul_u32_u24 v92, 272, v92
    v_lshl_add_u32 v92, v2, 4, v92
    v_add_u32 v92, 1024, v92
    v_mov_b32 v95, v3
    s_lshl_b32 s38, s3, 16
    s_add_u32 s38, s38, 0x2a0000
    s_lshl_b32 s40, s3, 12
    v_mov_b32 v76, 0
    v_mov_b32 v77, 0
    v_mov_b32 v78, 0
    v_mov_b32 v79, 0
    s_lshr_b32 s45, s3, 2
    s_lshl_b32 s46, s45, 8
    s_add_u32 s46, s46, s2
    s_and_b32 s47, s3, 3
    s_mul_i32 s48, s45, 17408
    s_add_u32 s48, s48, 106496
    v_lshrrev_b32 v240, 5, v1
    v_bfe_u32 v241, v1, 4, 1
    v_bfe_u32 v242, v1, 2, 2
    v_and_b32 v243, 3, v1
    s_mov_b32 s14, 1835008
    s_mov_b32 s15, 0x00020000
    s_cmp_ge_u32 s46, 224
    s_cbranch_scc1 k2_shw2
    s_cmp_lt_u32 s47, 2
    s_cselect_b32 s12, s16, s18
    s_cselect_b32 s13, s17, s19
    s_and_b32 s50, s46, 31
    s_lshr_b32 s51, s46, 5
    s_mul_i32 s52, s50, 57344
    s_and_b32 s53, s47, 1
    s_mul_i32 s53, s53, 28672
    s_add_u32 s52, s52, s53
    s_lshl_b32 s53, s51, 9
    s_add_u32 s52, s52, s53
    s_movk_i32 s53, 7168
    v_and_b32 v238, 31, v1
    v_lshlrev_b32 v238, 4, v238
    v_mul_u32_u24 v236, 3584, v240
    v_add_u32 v238, v238, v236
    v_lshrrev_b32 v236, 1, v242
    v_lshl_add_u32 v236, v240, 2, v236
    v_lshl_add_u32 v236, v241, 3, v236
    v_mul_u32_u24 v236, 1088, v236
    v_and_b32 v237, 1, v242
    v_lshl_add_u32 v236, v237, 9, v236
    v_and_b32 v237, 1, v243
    v_lshl_add_u32 v236, v237, 4, v236
    v_lshrrev_b32 v237, 1, v243
    v_lshl_add_u32 v236, v237, 3, v236
    s_lshr_b32 s54, s47, 1
    s_lshl_b32 s54, s54, 3
    s_and_b32 s55, s47, 1
    s_add_u32 s54, s54, s55
    s_lshl_b32 s55, s54, 5
    s_add_u32 s55, s55, s48
    v_add_u32 v236, s55, v236
    v_add_u32 v237, 2176, v236
    s_lshl_b32 s55, s51, 4
    s_add_u32 s54, s54, s55
    s_lshl_b32 s54, s54, 5
    s_add_u32 s54, s54, s50
    s_lshl_b32 s54, s54, 10
    s_add_u32 s54, s54, 0x950000
    s_mov_b32 s55, 65536
    s_branch k2_shdone
k2_shw2:
    s_mov_b32 s12, s20
    s_mov_b32 s13, s21
    s_sub_u32 s50, s46, 224
    s_lshl_b32 s52, s50, 14
    s_lshl_b32 s53, s47, 12
    s_add_u32 s52, s52, s53
    s_movk_i32 s53, 1024
    v_mov_b32 v238, v3
    v_lshl_add_u32 v236, v240, 3, v242
    v_mul_u32_u24 v236, 1088, v236
    v_and_b32 v237, 1, v243
    v_lshl_add_u32 v236, v237, 5, v236
    v_lshrrev_b32 v237, 1, v243
    v_lshl_add_u32 v237, v241, 1, v237
    v_lshl_add_u32 v236, v237, 3, v236
    s_lshl_b32 s55, s47, 8
    s_add_u32 s55, s55, s48
    v_add_u32 v236, s55, v236
    v_add_u32 v237, 4352, v236
    s_mul_i32 s54, s47, 458752
    s_lshl_b32 s55, s50, 10
    s_add_u32 s54, s54, s55
    s_add_u32 s54, s54, 0xcd0000
    s_mov_b32 s55, 114688
    s_cmp_lt_u32 s46, 336
    s_cbranch_scc1 k2_shdone
    s_mov_b32 s54, 0x40000000
k2_shdone:
    s_mul_i32 s49, s47, 4352
    s_add_u32 s48, s48, s49
    s_waitcnt vmcnt(0)
    s_barrier
    s_add_u32 m0, s27, 16384
    s_add_u32 s28, s28, 8192
    buffer_load_dwordx4 v3, s[4:7], s28 offen lds
    s_add_u32 m0, s27, 24576
    s_add_u32 s28, s28, 8192
    buffer_load_dwordx4 v3, s[4:7], s28 offen lds
    s_add_u32 m0, s27, 32768
    s_add_u32 s28, s28, 8192
    buffer_load_dwordx4 v3, s[4:7], s28 offen lds
    s_add_u32 m0, s27, 40960
    s_add_u32 s28, s28, 8192
    buffer_load_dwordx4 v3, s[4:7], s28 offen lds
    ds_read_b128 v[96:99], v3 offset:0
    ds_read_b128 v[100:103], v3 offset:2112
    ds_read_b128 v[104:107], v3 offset:4224
    ds_read_b128 v[108:111], v3 offset:6336
    s_waitcnt lgkmcnt(3)
    v_mfma_f32_32x32x16_bf16 v[24:39], v[96:99], v[4:7], 0
    s_waitcnt lgkmcnt(2)
    v_mfma_f32_32x32x16_bf16 v[40:55], v[100:103], v[4:7], 0
    s_waitcnt lgkmcnt(1)
    v_mfma_f32_32x32x16_bf16 v[56:71], v[104:107], v[4:7], 0
    s_waitcnt lgkmcnt(0)
    v_mfma_f32_32x32x16_bf16 v[8:23], v[108:111], v[4:7], 0
    ds_read_b128 v[80:83], v3 offset:2112
    ds_read_b128 v[88:91], v92 offset:544
    ds_read_b128 v[84:87], v92
    s_nop 3
    v_max_f32 v72, v24, v25
    v_max_f32 v73, v26, v27
    v_max3_f32 v72, v28, v29, v72
    v_max3_f32 v73, v30, v31, v73
    v_max3_f32 v72, v32, v33, v72
    v_max3_f32 v73, v34, v35, v73
    v_max3_f32 v72, v36, v37, v72
    v_max3_f32 v73, v38, v39, v73
    v_max3_f32 v72, v40, v41, v72
    v_max3_f32 v73, v42, v43, v73
    v_max3_f32 v72, v44, v45, v72
    v_max3_f32 v73, v46, v47, v73
    v_max3_f32 v72, v48, v49, v72
    v_max3_f32 v73, v50, v51, v73
    v_max3_f32 v72, v52, v53, v72
    v_max3_f32 v73, v54, v55, v73
    v_max3_f32 v72, v56, v57, v72
    v_max3_f32 v73, v58, v59, v73
    v_max3_f32 v72, v60, v61, v72
    v_max3_f32 v73, v62, v63, v73
    v_max3_f32 v72, v64, v65, v72
    v_max3_f32 v73, v66, v67, v73
    v_max3_f32 v72, v68, v69, v72
    v_max3_f32 v73, v70, v71, v73
    v_max3_f32 v72, v8, v9, v72
    v_max3_f32 v73, v10, v11, v73
    v_max3_f32 v72, v12, v13, v72
    v_max3_f32 v73, v14, v15, v73
    v_max3_f32 v72, v16, v17, v72
    v_max3_f32 v73, v18, v19, v73
    v_max3_f32 v72, v20, v21, v72
    v_max3_f32 v73, v22, v23, v73
    v_max_f32 v72, v72, v73
    v_mov_b32 v73, v72
    s_nop 1
    v_permlane32_swap_b32 v72, v73
    s_nop 1
    v_max_f32 v72, v72, v73
    v_sub_f32 v8, 0xc2b00000, v72
    v_mov_b32 v9, v8
    v_mov_b32 v10, v8
    v_mov_b32 v11, v8
    v_mov_b32 v12, v8
    v_mov_b32 v13, v8
    v_mov_b32 v14, v8
    v_mov_b32 v15, v8
    v_mov_b32 v16, v8
    v_mov_b32 v17, v8
    v_mov_b32 v18, v8
    v_mov_b32 v19, v8
    v_mov_b32 v20, v8
    v_mov_b32 v21, v8
    v_mov_b32 v22, v8
    v_mov_b32 v23, v8
    v_mov_b32 v56, 0
    v_mov_b32 v57, 0
    v_mov_b32 v58, 0
    v_mov_b32 v59, 0
    v_mov_b32 v60, 0
    v_mov_b32 v61, 0
    v_mov_b32 v62, 0
    v_mov_b32 v63, 0
    v_mov_b32 v64, 0
    v_mov_b32 v65, 0
    v_mov_b32 v66, 0
    v_mov_b32 v67, 0
    v_mov_b32 v68, 0
    v_mov_b32 v69, 0
    v_mov_b32 v70, 0
    v_mov_b32 v71, 0
    v_mfma_f32_32x32x16_bf16 v[24:39], v[96:99], v[4:7], v[8:23]
    s_nop 11
    s_setprio 3
    v_exp_f32 v24, v24
    v_exp_f32 v25, v25
    s_waitcnt lgkmcnt(1)
    v_mfma_f32_32x32x16_bf16 v[56:71], v[88:91], v[76:79], v[56:71]
    s_add_u32 m0, s48, 0
    s_nop 0
    buffer_load_dwordx4 v238, s[12:15], s52 offen lds
    s_add_u32 s52, s52, s53
    v_exp_f32 v26, v26
    v_exp_f32 v27, v27
    v_cvt_pk_bf16_f32 v72, v24, v25
    v_exp_f32 v28, v28
    v_exp_f32 v29, v29
    v_mfma_f32_32x32x16_bf16 v[40:55], v[80:83], v[4:7], v[8:23]
    ds_read_b128 v[80:83], v95 offset:4224
    v_cvt_pk_bf16_f32 v73, v26, v27
    v_exp_f32 v30, v30
    v_exp_f32 v31, v31
    s_add_u32 m0, s27, 49152
    s_add_u32 s28, s28, 8192
    buffer_load_dwordx4 v3, s[4:7], s28 offen lds
    v_cvt_pk_bf16_f32 v74, v28, v29
    v_exp_f32 v32, v32
    v_exp_f32 v33, v33
    v_cvt_pk_bf16_f32 v75, v30, v31
    v_exp_f32 v34, v34
    v_exp_f32 v35, v35
    s_waitcnt lgkmcnt(1)
    v_mfma_f32_32x32x16_bf16 v[56:71], v[84:87], v[72:75], v[56:71]
    ds_read_b128 v[88:91], v92 offset:544
    ds_read_b128 v[84:87], v92 offset:2112
    v_cvt_pk_bf16_f32 v76, v32, v33
    v_exp_f32 v36, v36
    v_exp_f32 v37, v37
    v_cvt_pk_bf16_f32 v77, v34, v35
    v_exp_f32 v38, v38
    v_exp_f32 v39, v39
    v_cvt_pk_bf16_f32 v78, v36, v37
    v_cvt_pk_bf16_f32 v79, v38, v39
    s_setprio 2
    v_exp_f32 v40, v40
    v_exp_f32 v41, v41
    s_waitcnt lgkmcnt(1)
    v_mfma_f32_32x32x16_bf16 v[56:71], v[88:91], v[76:79], v[56:71]
    v_exp_f32 v42, v42
    v_exp_f32 v43, v43
    v_cvt_pk_bf16_f32 v72, v40, v41
    v_exp_f32 v44, v44
    v_exp_f32 v45, v45
    v_mfma_f32_32x32x16_bf16 v[24:39], v[80:83], v[4:7], v[8:23]
    ds_read_b128 v[80:83], v95 offset:6336
    v_cvt_pk_bf16_f32 v73, v42, v43
    v_exp_f32 v46, v46
    v_exp_f32 v47, v47
    s_add_u32 m0, s27, 57344
    s_add_u32 s28, s28, 8192
    buffer_load_dwordx4 v3, s[4:7], s28 offen lds
    v_cvt_pk_bf16_f32 v74, v44, v45
    v_exp_f32 v48, v48
    v_exp_f32 v49, v49
    v_cvt_pk_bf16_f32 v75, v46, v47
    v_exp_f32 v50, v50
    v_exp_f32 v51, v51
    s_waitcnt lgkmcnt(1)
    v_mfma_f32_32x32x16_bf16 v[56:71], v[84:87], v[72:75], v[56:71]
    ds_read_b128 v[88:91], v92 offset:2656
    ds_read_b128 v[84:87], v92 offset:4224
    v_cvt_pk_bf16_f32 v76, v48, v49
    v_exp_f32 v52, v52
    v_exp_f32 v53, v53
    v_cvt_pk_bf16_f32 v77, v50, v51
    v_exp_f32 v54, v54
    v_exp_f32 v55, v55
    v_cvt_pk_bf16_f32 v78, v52, v53
    v_cvt_pk_bf16_f32 v79, v54, v55
    s_setprio 1
    v_exp_f32 v24, v24
    v_exp_f32 v25, v25
    s_waitcnt lgkmcnt(1)
    v_mfma_f32_32x32x16_bf16 v[56:71], v[88:91], v[76:79], v[56:71]
    s_add_u32 m0, s48, 1088
    s_nop 0
    buffer_load_dwordx4 v238, s[12:15], s52 offen lds
    s_add_u32 s52, s52, s53
    v_exp_f32 v26, v26
    v_exp_f32 v27, v27
    v_cvt_pk_bf16_f32 v72, v24, v25
    v_exp_f32 v28, v28
    v_exp_f32 v29, v29
    v_mfma_f32_32x32x16_bf16 v[40:55], v[80:83], v[4:7], v[8:23]
    ds_read_b128 v[80:83], v95 offset:8448
    v_cvt_pk_bf16_f32 v73, v26, v27
    v_exp_f32 v30, v30
    v_exp_f32 v31, v31
    s_add_u32 m0, s27, 65536
    s_add_u32 s28, s28, 8192
    buffer_load_dwordx4 v3, s[4:7], s28 offen lds
    v_cvt_pk_bf16_f32 v74, v28, v29
    v_exp_f32 v32, v32
    v_exp_f32 v33, v33
    v_cvt_pk_bf16_f32 v75, v30, v31
    v_exp_f32 v34, v34
    v_exp_f32 v35, v35
    s_waitcnt lgkmcnt(1)
    v_mfma_f32_32x32x16_bf16 v[56:71], v[84:87], v[72:75], v[56:71]
    ds_read_b128 v[88:91], v92 offset:4768
    ds_read_b128 v[84:87], v92 offset:6336
    v_cvt_pk_bf16_f32 v76, v32, v33
    v_exp_f32 v36, v36
    v_exp_f32 v37, v37
    v_cvt_pk_bf16_f32 v77, v34, v35
    v_exp_f32 v38, v38
    v_exp_f32 v39, v39
    v_cvt_pk_bf16_f32 v78, v36, v37
    v_cvt_pk_bf16_f32 v79, v38, v39
    s_setprio 0
    v_exp_f32 v40, v40
    v_exp_f32 v41, v41
    s_waitcnt lgkmcnt(1)
    v_mfma_f32_32x32x16_bf16 v[56:71], v[88:91], v[76:79], v[56:71]
    v_exp_f32 v42, v42
    v_exp_f32 v43, v43
    v_cvt_pk_bf16_f32 v72, v40, v41
    v_exp_f32 v44, v44
    v_exp_f32 v45, v45
    v_mfma_f32_32x32x16_bf16 v[24:39], v[80:83], v[4:7], v[8:23]
    ds_read_b128 v[80:83], v95 offset:10560
    v_cvt_pk_bf16_f32 v73, v42, v43
    v_exp_f32 v46, v46
    v_exp_f32 v47, v47
    s_add_u32 m0, s27, 73728
    s_add_u32 s28, s28, 8192
    buffer_load_dwordx4 v3, s[4:7], s28 offen lds
    v_cvt_pk_bf16_f32 v74, v44, v45
    v_exp_f32 v48, v48
    v_exp_f32 v49, v49
    v_cvt_pk_bf16_f32 v75, v46, v47
    v_exp_f32 v50, v50
    v_exp_f32 v51, v51
    s_waitcnt lgkmcnt(1)
    v_mfma_f32_32x32x16_bf16 v[56:71], v[84:87], v[72:75], v[56:71]
    ds_read_b128 v[88:91], v92 offset:6880
    ds_read_b128 v[84:87], v92 offset:8448
    v_cvt_pk_bf16_f32 v76, v48, v49
    v_exp_f32 v52, v52
    v_exp_f32 v53, v53
    v_cvt_pk_bf16_f32 v77, v50, v51
    v_exp_f32 v54, v54
    v_exp_f32 v55, v55
    v_cvt_pk_bf16_f32 v78, v52, v53
    v_cvt_pk_bf16_f32 v79, v54, v55
    s_waitcnt lgkmcnt(1) vmcnt(6)
    s_barrier
    s_setprio 3
    v_exp_f32 v24, v24
    v_exp_f32 v25, v25
    s_waitcnt lgkmcnt(1)
    v_mfma_f32_32x32x16_bf16 v[56:71], v[88:91], v[76:79], v[56:71]
    s_add_u32 m0, s48, 2176
    s_nop 0
    buffer_load_dwordx4 v238, s[12:15], s52 offen lds
    s_add_u32 s52, s52, s53
    v_exp_f32 v26, v26
    v_exp_f32 v27, v27
    v_cvt_pk_bf16_f32 v72, v24, v25
    v_exp_f32 v28, v28
    v_exp_f32 v29, v29
    v_mfma_f32_32x32x16_bf16 v[40:55], v[80:83], v[4:7], v[8:23]
    ds_read_b128 v[80:83], v95 offset:12672
    v_cvt_pk_bf16_f32 v73, v26, v27
    v_exp_f32 v30, v30
    v_exp_f32 v31, v31
    s_add_u32 m0, s27, 81920
    s_add_u32 s28, s28, 8192
    buffer_load_dwordx4 v3, s[4:7], s28 offen lds
    v_cvt_pk_bf16_f32 v74, v28, v29
    v_exp_f32 v32, v32
    v_exp_f32 v33, v33
    v_cvt_pk_bf16_f32 v75, v30, v31
    v_exp_f32 v34, v34
    v_exp_f32 v35, v35
    s_waitcnt lgkmcnt(1)
    v_mfma_f32_32x32x16_bf16 v[56:71], v[84:87], v[72:75], v[56:71]
    ds_read_b128 v[88:91], v92 offset:8992
    ds_read_b128 v[84:87], v92 offset:10560
    v_cvt_pk_bf16_f32 v76, v32, v33
    v_exp_f32 v36, v36
    v_exp_f32 v37, v37
    v_cvt_pk_bf16_f32 v77, v34, v35
    v_exp_f32 v38, v38
    v_exp_f32 v39, v39
    v_cvt_pk_bf16_f32 v78, v36, v37
    v_cvt_pk_bf16_f32 v79, v38, v39
    v_exp_f32 v40, v40
    v_exp_f32 v41, v41
    s_waitcnt lgkmcnt(1)
    v_mfma_f32_32x32x16_bf16 v[56:71], v[88:91], v[76:79], v[56:71]
    v_exp_f32 v42, v42
    v_exp_f32 v43, v43
    v_cvt_pk_bf16_f32 v72, v40, v41
    v_exp_f32 v44, v44
    v_exp_f32 v45, v45
    v_mfma_f32_32x32x16_bf16 v[24:39], v[80:83], v[4:7], v[8:23]
    ds_read_b128 v[80:83], v95 offset:14784
    v_cvt_pk_bf16_f32 v73, v42, v43
    v_exp_f32 v46, v46
    v_exp_f32 v47, v47
    s_add_u32 m0, s27, 90112
    s_add_u32 s28, s28, 8192
    buffer_load_dwordx4 v3, s[4:7], s28 offen lds
    v_cvt_pk_bf16_f32 v74, v44, v45
    v_exp_f32 v48, v48
    v_exp_f32 v49, v49
    v_cvt_pk_bf16_f32 v75, v46, v47
    v_exp_f32 v50, v50
    v_exp_f32 v51, v51
    s_waitcnt lgkmcnt(1)
    v_mfma_f32_32x32x16_bf16 v[56:71], v[84:87], v[72:75], v[56:71]
    ds_read_b128 v[88:91], v92 offset:11104
    ds_read_b128 v[84:87], v92 offset:12672
    v_cvt_pk_bf16_f32 v76, v48, v49
    v_exp_f32 v52, v52
    v_exp_f32 v53, v53
    v_cvt_pk_bf16_f32 v77, v50, v51
    v_exp_f32 v54, v54
    v_exp_f32 v55, v55
    v_cvt_pk_bf16_f32 v78, v52, v53
    v_cvt_pk_bf16_f32 v79, v54, v55
    v_exp_f32 v24, v24
    v_exp_f32 v25, v25
    s_waitcnt lgkmcnt(1)
    v_mfma_f32_32x32x16_bf16 v[56:71], v[88:91], v[76:79], v[56:71]
    s_add_u32 m0, s48, 3264
    s_nop 0
    buffer_load_dwordx4 v238, s[12:15], s52 offen lds
    s_add_u32 s52, s52, s53
    v_exp_f32 v26, v26
    v_exp_f32 v27, v27
    v_cvt_pk_bf16_f32 v72, v24, v25
    v_exp_f32 v28, v28
    v_exp_f32 v29, v29
    v_mfma_f32_32x32x16_bf16 v[40:55], v[80:83], v[4:7], v[8:23]
    ds_read_b128 v[80:83], v95 offset:16896
    v_cvt_pk_bf16_f32 v73, v26, v27
    v_exp_f32 v30, v30
    v_exp_f32 v31, v31
    s_add_u32 m0, s27, 98304
    s_add_u32 s28, s28, 8192
    buffer_load_dwordx4 v3, s[4:7], s28 offen lds
    v_cvt_pk_bf16_f32 v74, v28, v29
    v_exp_f32 v32, v32
    v_exp_f32 v33, v33
    v_cvt_pk_bf16_f32 v75, v30, v31
    v_exp_f32 v34, v34
    v_exp_f32 v35, v35
    s_waitcnt lgkmcnt(1)
    v_mfma_f32_32x32x16_bf16 v[56:71], v[84:87], v[72:75], v[56:71]
    ds_read_b128 v[88:91], v92 offset:13216
    ds_read_b128 v[84:87], v92 offset:14784
    v_cvt_pk_bf16_f32 v76, v32, v33
    v_exp_f32 v36, v36
    v_exp_f32 v37, v37
    v_cvt_pk_bf16_f32 v77, v34, v35
    v_exp_f32 v38, v38
    v_exp_f32 v39, v39
    v_cvt_pk_bf16_f32 v78, v36, v37
    v_cvt_pk_bf16_f32 v79, v38, v39
    v_exp_f32 v40, v40
    v_exp_f32 v41, v41
    s_waitcnt lgkmcnt(1)
    v_mfma_f32_32x32x16_bf16 v[56:71], v[88:91], v[76:79], v[56:71]
    v_exp_f32 v42, v42
    v_exp_f32 v43, v43
    v_cvt_pk_bf16_f32 v72, v40, v41
    v_exp_f32 v44, v44
    v_exp_f32 v45, v45
    v_mfma_f32_32x32x16_bf16 v[24:39], v[80:83], v[4:7], v[8:23]
    ds_read_b128 v[80:83], v95 offset:19008
    v_cvt_pk_bf16_f32 v73, v42, v43
    v_exp_f32 v46, v46
    v_exp_f32 v47, v47
    v_cvt_pk_bf16_f32 v74, v44, v45
    v_exp_f32 v48, v48
    v_exp_f32 v49, v49
    v_cvt_pk_bf16_f32 v75, v46, v47
    v_exp_f32 v50, v50
    v_exp_f32 v51, v51
    s_waitcnt lgkmcnt(1)
    v_mfma_f32_32x32x16_bf16 v[56:71], v[84:87], v[72:75], v[56:71]
    ds_read_b128 v[88:91], v92 offset:15328
    ds_read_b128 v[84:87], v92 offset:16896
    v_cvt_pk_bf16_f32 v76, v48, v49
    v_exp_f32 v52, v52
    v_exp_f32 v53, v53
    v_cvt_pk_bf16_f32 v77, v50, v51
    v_exp_f32 v54, v54
    v_exp_f32 v55, v55
    v_cvt_pk_bf16_f32 v78, v52, v53
    v_cvt_pk_bf16_f32 v79, v54, v55
    s_setprio 2
    v_exp_f32 v24, v24
    v_exp_f32 v25, v25
    s_waitcnt lgkmcnt(1)
    v_mfma_f32_32x32x16_bf16 v[56:71], v[88:91], v[76:79], v[56:71]
    v_exp_f32 v26, v26
    v_exp_f32 v27, v27
    v_cvt_pk_bf16_f32 v72, v24, v25
    v_exp_f32 v28, v28
    v_exp_f32 v29, v29
    v_mfma_f32_32x32x16_bf16 v[40:55], v[80:83], v[4:7], v[8:23]
    ds_read_b128 v[80:83], v95 offset:21120
    v_cvt_pk_bf16_f32 v73, v26, v27
    v_exp_f32 v30, v30
    v_exp_f32 v31, v31
    v_cvt_pk_bf16_f32 v74, v28, v29
    v_exp_f32 v32, v32
    v_exp_f32 v33, v33
    v_cvt_pk_bf16_f32 v75, v30, v31
    v_exp_f32 v34, v34
    v_exp_f32 v35, v35
    s_waitcnt lgkmcnt(1)
    v_mfma_f32_32x32x16_bf16 v[56:71], v[84:87], v[72:75], v[56:71]
    ds_read_b128 v[88:91], v92 offset:17440
    ds_read_b128 v[84:87], v92 offset:19008
    v_cvt_pk_bf16_f32 v76, v32, v33
    v_exp_f32 v36, v36
    v_exp_f32 v37, v37
    v_cvt_pk_bf16_f32 v77, v34, v35
    v_exp_f32 v38, v38
    v_exp_f32 v39, v39
    v_cvt_pk_bf16_f32 v78, v36, v37
    v_cvt_pk_bf16_f32 v79, v38, v39
    v_exp_f32 v40, v40
    v_exp_f32 v41, v41
    s_waitcnt lgkmcnt(1)
    v_mfma_f32_32x32x16_bf16 v[56:71], v[88:91], v[76:79], v[56:71]
    s_add_u32 m0, s27, 141312
    s_lshl_b32 s36, s24, 10
    buffer_load_dwordx4 v3, s[8:11], s36 offen lds
    v_exp_f32 v42, v42
    v_exp_f32 v43, v43
    v_cvt_pk_bf16_f32 v72, v40, v41
    v_exp_f32 v44, v44
    v_exp_f32 v45, v45
    v_mfma_f32_32x32x16_bf16 v[24:39], v[80:83], v[4:7], v[8:23]
    ds_read_b128 v[80:83], v95 offset:23232
    v_cvt_pk_bf16_f32 v73, v42, v43
    v_exp_f32 v46, v46
    v_exp_f32 v47, v47
    v_cvt_pk_bf16_f32 v74, v44, v45
    v_exp_f32 v48, v48
    v_exp_f32 v49, v49
    v_cvt_pk_bf16_f32 v75, v46, v47
    v_exp_f32 v50, v50
    v_exp_f32 v51, v51
    s_waitcnt lgkmcnt(1)
    v_mfma_f32_32x32x16_bf16 v[56:71], v[84:87], v[72:75], v[56:71]
    ds_read_b128 v[88:91], v92 offset:19552
    ds_read_b128 v[84:87], v92 offset:21120
    v_cvt_pk_bf16_f32 v76, v48, v49
    v_exp_f32 v52, v52
    v_exp_f32 v53, v53
    v_cvt_pk_bf16_f32 v77, v50, v51
    v_exp_f32 v54, v54
    v_exp_f32 v55, v55
    v_cvt_pk_bf16_f32 v78, v52, v53
    v_cvt_pk_bf16_f32 v79, v54, v55
    v_exp_f32 v24, v24
    v_exp_f32 v25, v25
    s_waitcnt lgkmcnt(1)
    v_mfma_f32_32x32x16_bf16 v[56:71], v[88:91], v[76:79], v[56:71]
    v_exp_f32 v26, v26
    v_exp_f32 v27, v27
    v_cvt_pk_bf16_f32 v72, v24, v25
    v_exp_f32 v28, v28
    v_exp_f32 v29, v29
    v_mfma_f32_32x32x16_bf16 v[40:55], v[80:83], v[4:7], v[8:23]
    ds_read_b128 v[80:83], v95 offset:25344
    v_cvt_pk_bf16_f32 v73, v26, v27
    v_exp_f32 v30, v30
    v_exp_f32 v31, v31
    s_add_u32 s39, s38, 0
    buffer_load_dwordx4 v[96:99], v3, s[4:7], s39 offen offset:0
    v_cvt_pk_bf16_f32 v74, v28, v29
    v_exp_f32 v32, v32
    v_exp_f32 v33, v33
    v_cvt_pk_bf16_f32 v75, v30, v31
    v_exp_f32 v34, v34
    v_exp_f32 v35, v35
    s_waitcnt lgkmcnt(1)
    v_mfma_f32_32x32x16_bf16 v[56:71], v[84:87], v[72:75], v[56:71]
    ds_read_b128 v[88:91], v92 offset:21664
    ds_read_b128 v[84:87], v92 offset:23232
    v_cvt_pk_bf16_f32 v76, v32, v33
    v_exp_f32 v36, v36
    v_exp_f32 v37, v37
    v_cvt_pk_bf16_f32 v77, v34, v35
    v_exp_f32 v38, v38
    v_exp_f32 v39, v39
    v_cvt_pk_bf16_f32 v78, v36, v37
    v_cvt_pk_bf16_f32 v79, v38, v39
    v_exp_f32 v40, v40
    v_exp_f32 v41, v41
    s_waitcnt lgkmcnt(1)
    v_mfma_f32_32x32x16_bf16 v[56:71], v[88:91], v[76:79], v[56:71]
    s_min_u32 s37, s27, 5120
    s_add_u32 m0, s37, 149504
    s_add_u32 s37, s37, 4096
    buffer_load_dwordx4 v3, s[4:7], s37 offen lds
    v_exp_f32 v42, v42
    v_exp_f32 v43, v43
    v_cvt_pk_bf16_f32 v72, v40, v41
    v_exp_f32 v44, v44
    v_exp_f32 v45, v45
    v_mfma_f32_32x32x16_bf16 v[24:39], v[80:83], v[4:7], v[8:23]
    ds_read_b128 v[80:83], v95 offset:27456
    v_cvt_pk_bf16_f32 v73, v42, v43
    v_exp_f32 v46, v46
    v_exp_f32 v47, v47
    s_add_u32 s39, s38, 16384
    buffer_load_dwordx4 v[100:103], v3, s[4:7], s39 offen offset:0
    v_cvt_pk_bf16_f32 v74, v44, v45
    v_exp_f32 v48, v48
    v_exp_f32 v49, v49
    v_cvt_pk_bf16_f32 v75, v46, v47
    v_exp_f32 v50, v50
    v_exp_f32 v51, v51
    s_waitcnt lgkmcnt(1)
    v_mfma_f32_32x32x16_bf16 v[56:71], v[84:87], v[72:75], v[56:71]
    ds_read_b128 v[88:91], v92 offset:23776
    ds_read_b128 v[84:87], v92 offset:25344
    v_cvt_pk_bf16_f32 v76, v48, v49
    v_exp_f32 v52, v52
    v_exp_f32 v53, v53
    v_cvt_pk_bf16_f32 v77, v50, v51
    v_exp_f32 v54, v54
    v_exp_f32 v55, v55
    v_cvt_pk_bf16_f32 v78, v52, v53
    v_cvt_pk_bf16_f32 v79, v54, v55
    s_setprio 1
    v_exp_f32 v24, v24
    v_exp_f32 v25, v25
    s_waitcnt lgkmcnt(1)
    v_mfma_f32_32x32x16_bf16 v[56:71], v[88:91], v[76:79], v[56:71]
    v_exp_f32 v26, v26
    v_exp_f32 v27, v27
    v_cvt_pk_bf16_f32 v72, v24, v25
    v_exp_f32 v28, v28
    v_exp_f32 v29, v29
    v_mfma_f32_32x32x16_bf16 v[40:55], v[80:83], v[4:7], v[8:23]
    ds_read_b128 v[80:83], v95 offset:29568
    v_cvt_pk_bf16_f32 v73, v26, v27
    v_exp_f32 v30, v30
    v_exp_f32 v31, v31
    s_add_u32 s39, s38, 32768
    buffer_load_dwordx4 v[104:107], v3, s[4:7], s39 offen offset:0
    v_cvt_pk_bf16_f32 v74, v28, v29
    v_exp_f32 v32, v32
    v_exp_f32 v33, v33
    v_cvt_pk_bf16_f32 v75, v30, v31
    v_exp_f32 v34, v34
    v_exp_f32 v35, v35
    s_waitcnt lgkmcnt(1)
    v_mfma_f32_32x32x16_bf16 v[56:71], v[84:87], v[72:75], v[56:71]
    ds_read_b128 v[88:91], v92 offset:25888
    ds_read_b128 v[84:87], v92 offset:27456
    v_cvt_pk_bf16_f32 v76, v32, v33
    v_exp_f32 v36, v36
    v_exp_f32 v37, v37
    v_cvt_pk_bf16_f32 v77, v34, v35
    v_exp_f32 v38, v38
    v_exp_f32 v39, v39
    v_cvt_pk_bf16_f32 v78, v36, v37
    v_cvt_pk_bf16_f32 v79, v38, v39
    v_exp_f32 v40, v40
    v_exp_f32 v41, v41
    s_waitcnt lgkmcnt(1)
    v_mfma_f32_32x32x16_bf16 v[56:71], v[88:91], v[76:79], v[56:71]
    v_exp_f32 v42, v42
    v_exp_f32 v43, v43
    v_cvt_pk_bf16_f32 v72, v40, v41
    v_exp_f32 v44, v44
    v_exp_f32 v45, v45
    v_mfma_f32_32x32x16_bf16 v[24:39], v[80:83], v[4:7], v[8:23]
    ds_read_b128 v[80:83], v95 offset:31680
    v_cvt_pk_bf16_f32 v73, v42, v43
    v_exp_f32 v46, v46
    v_exp_f32 v47, v47
    s_add_u32 s39, s38, 49152
    buffer_load_dwordx4 v[108:111], v3, s[4:7], s39 offen offset:0
    v_cvt_pk_bf16_f32 v74, v44, v45
    v_exp_f32 v48, v48
    v_exp_f32 v49, v49
    v_cvt_pk_bf16_f32 v75, v46, v47
    v_exp_f32 v50, v50
    v_exp_f32 v51, v51
    s_waitcnt lgkmcnt(1)
    v_mfma_f32_32x32x16_bf16 v[56:71], v[84:87], v[72:75], v[56:71]
    ds_read_b128 v[88:91], v92 offset:28000
    ds_read_b128 v[84:87], v92 offset:29568
    v_cvt_pk_bf16_f32 v76, v48, v49
    v_exp_f32 v52, v52
    v_exp_f32 v53, v53
    v_cvt_pk_bf16_f32 v77, v50, v51
    v_exp_f32 v54, v54
    v_exp_f32 v55, v55
    v_cvt_pk_bf16_f32 v78, v52, v53
    v_cvt_pk_bf16_f32 v79, v54, v55
    v_exp_f32 v24, v24
    v_exp_f32 v25, v25
    s_waitcnt lgkmcnt(1)
    v_mfma_f32_32x32x16_bf16 v[56:71], v[88:91], v[76:79], v[56:71]
    v_exp_f32 v26, v26
    v_exp_f32 v27, v27
    v_cvt_pk_bf16_f32 v72, v24, v25
    v_exp_f32 v28, v28
    v_exp_f32 v29, v29
    v_mfma_f32_32x32x16_bf16 v[40:55], v[80:83], v[4:7], v[8:23]
    ds_read_b128 v[80:83], v95 offset:33792
    v_cvt_pk_bf16_f32 v73, v26, v27
    v_exp_f32 v30, v30
    v_exp_f32 v31, v31
    s_add_u32 s39, s38, 0
    buffer_load_dwordx4 v[112:115], v3, s[4:7], s39 offen offset:1024
    v_cvt_pk_bf16_f32 v74, v28, v29
    v_exp_f32 v32, v32
    v_exp_f32 v33, v33
    v_cvt_pk_bf16_f32 v75, v30, v31
    v_exp_f32 v34, v34
    v_exp_f32 v35, v35
    s_waitcnt lgkmcnt(1)
    v_mfma_f32_32x32x16_bf16 v[56:71], v[84:87], v[72:75], v[56:71]
    ds_read_b128 v[88:91], v92 offset:30112
    ds_read_b128 v[84:87], v92 offset:31680
    v_cvt_pk_bf16_f32 v76, v32, v33
    v_exp_f32 v36, v36
    v_exp_f32 v37, v37
    v_cvt_pk_bf16_f32 v77, v34, v35
    v_exp_f32 v38, v38
    v_exp_f32 v39, v39
    v_cvt_pk_bf16_f32 v78, v36, v37
    v_cvt_pk_bf16_f32 v79, v38, v39
    v_exp_f32 v40, v40
    v_exp_f32 v41, v41
    s_waitcnt lgkmcnt(1)
    v_mfma_f32_32x32x16_bf16 v[56:71], v[88:91], v[76:79], v[56:71]
    v_exp_f32 v42, v42
    v_exp_f32 v43, v43
    v_cvt_pk_bf16_f32 v72, v40, v41
    v_exp_f32 v44, v44
    v_exp_f32 v45, v45
    v_mfma_f32_32x32x16_bf16 v[24:39], v[80:83], v[4:7], v[8:23]
    ds_read_b128 v[80:83], v95 offset:35904
    v_cvt_pk_bf16_f32 v73, v42, v43
    v_exp_f32 v46, v46
    v_exp_f32 v47, v47
    s_add_u32 s39, s38, 16384
    buffer_load_dwordx4 v[116:119], v3, s[4:7], s39 offen offset:1024
    v_cvt_pk_bf16_f32 v74, v44, v45
    v_exp_f32 v48, v48
    v_exp_f32 v49, v49
    v_cvt_pk_bf16_f32 v75, v46, v47
    v_exp_f32 v50, v50
    v_exp_f32 v51, v51
    s_waitcnt lgkmcnt(1)
    v_mfma_f32_32x32x16_bf16 v[56:71], v[84:87], v[72:75], v[56:71]
    ds_read_b128 v[88:91], v92 offset:32224
    ds_read_b128 v[84:87], v92 offset:33792
    v_cvt_pk_bf16_f32 v76, v48, v49
    v_exp_f32 v52, v52
    v_exp_f32 v53, v53
    v_cvt_pk_bf16_f32 v77, v50, v51
    v_exp_f32 v54, v54
    v_exp_f32 v55, v55
    v_cvt_pk_bf16_f32 v78, v52, v53
    v_cvt_pk_bf16_f32 v79, v54, v55
    s_setprio 0
    v_exp_f32 v24, v24
    v_exp_f32 v25, v25
    s_waitcnt lgkmcnt(1)
    v_mfma_f32_32x32x16_bf16 v[56:71], v[88:91], v[76:79], v[56:71]
    v_exp_f32 v26, v26
    v_exp_f32 v27, v27
    v_cvt_pk_bf16_f32 v72, v24, v25
    v_exp_f32 v28, v28
    v_exp_f32 v29, v29
    v_mfma_f32_32x32x16_bf16 v[40:55], v[80:83], v[4:7], v[8:23]
    ds_read_b128 v[80:83], v95 offset:38016
    v_cvt_pk_bf16_f32 v73, v26, v27
    v_exp_f32 v30, v30
    v_exp_f32 v31, v31
    s_add_u32 s39, s38, 32768
    buffer_load_dwordx4 v[120:123], v3, s[4:7], s39 offen offset:1024
    v_cvt_pk_bf16_f32 v74, v28, v29
    v_exp_f32 v32, v32
    v_exp_f32 v33, v33
    v_cvt_pk_bf16_f32 v75, v30, v31
    v_exp_f32 v34, v34
    v_exp_f32 v35, v35
    s_waitcnt lgkmcnt(1)
    v_mfma_f32_32x32x16_bf16 v[56:71], v[84:87], v[72:75], v[56:71]
    ds_read_b128 v[88:91], v92 offset:34336
    ds_read_b128 v[84:87], v92 offset:35904
    v_cvt_pk_bf16_f32 v76, v32, v33
    v_exp_f32 v36, v36
    v_exp_f32 v37, v37
    v_cvt_pk_bf16_f32 v77, v34, v35
    v_exp_f32 v38, v38
    v_exp_f32 v39, v39
    v_cvt_pk_bf16_f32 v78, v36, v37
    v_cvt_pk_bf16_f32 v79, v38, v39
    v_exp_f32 v40, v40
    v_exp_f32 v41, v41
    s_waitcnt lgkmcnt(1)
    v_mfma_f32_32x32x16_bf16 v[56:71], v[88:91], v[76:79], v[56:71]
    v_exp_f32 v42, v42
    v_exp_f32 v43, v43
    v_cvt_pk_bf16_f32 v72, v40, v41
    v_exp_f32 v44, v44
    v_exp_f32 v45, v45
    v_mfma_f32_32x32x16_bf16 v[24:39], v[80:83], v[4:7], v[8:23]
    ds_read_b128 v[80:83], v95 offset:40128
    v_cvt_pk_bf16_f32 v73, v42, v43
    v_exp_f32 v46, v46
    v_exp_f32 v47, v47
    s_add_u32 s39, s38, 49152
    buffer_load_dwordx4 v[124:127], v3, s[4:7], s39 offen offset:1024
    v_cvt_pk_bf16_f32 v74, v44, v45
    v_exp_f32 v48, v48
    v_exp_f32 v49, v49
    v_cvt_pk_bf16_f32 v75, v46, v47
    v_exp_f32 v50, v50
    v_exp_f32 v51, v51
    s_waitcnt lgkmcnt(1)
    v_mfma_f32_32x32x16_bf16 v[56:71], v[84:87], v[72:75], v[56:71]
    ds_read_b128 v[88:91], v92 offset:36448
    ds_read_b128 v[84:87], v92 offset:38016
    v_cvt_pk_bf16_f32 v76, v48, v49
    v_exp_f32 v52, v52
    v_exp_f32 v53, v53
    v_cvt_pk_bf16_f32 v77, v50, v51
    v_exp_f32 v54, v54
    v_exp_f32 v55, v55
    v_cvt_pk_bf16_f32 v78, v52, v53
    v_cvt_pk_bf16_f32 v79, v54, v55
    v_exp_f32 v24, v24
    v_exp_f32 v25, v25
    s_waitcnt lgkmcnt(1)
    v_mfma_f32_32x32x16_bf16 v[56:71], v[88:91], v[76:79], v[56:71]
    v_exp_f32 v26, v26
    v_exp_f32 v27, v27
    v_cvt_pk_bf16_f32 v72, v24, v25
    v_exp_f32 v28, v28
    v_exp_f32 v29, v29
    v_mfma_f32_32x32x16_bf16 v[40:55], v[80:83], v[4:7], v[8:23]
    ds_read_b128 v[80:83], v95 offset:42240
    v_cvt_pk_bf16_f32 v73, v26, v27
    v_exp_f32 v30, v30
    v_exp_f32 v31, v31
    s_add_u32 s39, s38, 0
    buffer_load_dwordx4 v[128:131], v3, s[4:7], s39 offen offset:2048
    v_cvt_pk_bf16_f32 v74, v28, v29
    v_exp_f32 v32, v32
    v_exp_f32 v33, v33
    v_cvt_pk_bf16_f32 v75, v30, v31
    v_exp_f32 v34, v34
    v_exp_f32 v35, v35
    s_waitcnt lgkmcnt(1)
    v_mfma_f32_32x32x16_bf16 v[56:71], v[84:87], v[72:75], v[56:71]
    ds_read_b128 v[88:91], v92 offset:38560
    ds_read_b128 v[84:87], v92 offset:40128
    v_cvt_pk_bf16_f32 v76, v32, v33
    v_exp_f32 v36, v36
    v_exp_f32 v37, v37
    v_cvt_pk_bf16_f32 v77, v34, v35
    v_exp_f32 v38, v38
    v_exp_f32 v39, v39
    v_cvt_pk_bf16_f32 v78, v36, v37
    v_cvt_pk_bf16_f32 v79, v38, v39
    v_exp_f32 v40, v40
    v_exp_f32 v41, v41
    s_waitcnt lgkmcnt(1)
    v_mfma_f32_32x32x16_bf16 v[56:71], v[88:91], v[76:79], v[56:71]
    v_exp_f32 v42, v42
    v_exp_f32 v43, v43
    v_cvt_pk_bf16_f32 v72, v40, v41
    v_exp_f32 v44, v44
    v_exp_f32 v45, v45
    v_mfma_f32_32x32x16_bf16 v[24:39], v[80:83], v[4:7], v[8:23]
    ds_read_b128 v[80:83], v95 offset:44352
    v_cvt_pk_bf16_f32 v73, v42, v43
    v_exp_f32 v46, v46
    v_exp_f32 v47, v47
    s_add_u32 s39, s38, 16384
    buffer_load_dwordx4 v[132:135], v3, s[4:7], s39 offen offset:2048
    v_cvt_pk_bf16_f32 v74, v44, v45
    v_exp_f32 v48, v48
    v_exp_f32 v49, v49
    v_cvt_pk_bf16_f32 v75, v46, v47
    v_exp_f32 v50, v50
    v_exp_f32 v51, v51
    s_waitcnt lgkmcnt(1)
    v_mfma_f32_32x32x16_bf16 v[56:71], v[84:87], v[72:75], v[56:71]
    ds_read_b128 v[88:91], v92 offset:40672
    ds_read_b128 v[84:87], v92 offset:42240
    v_cvt_pk_bf16_f32 v76, v48, v49
    v_exp_f32 v52, v52
    v_exp_f32 v53, v53
    v_cvt_pk_bf16_f32 v77, v50, v51
    v_exp_f32 v54, v54
    v_exp_f32 v55, v55
    v_cvt_pk_bf16_f32 v78, v52, v53
    v_cvt_pk_bf16_f32 v79, v54, v55
    s_waitcnt lgkmcnt(1) vmcnt(9)
    s_barrier
    s_setprio 3
    v_exp_f32 v24, v24
    v_exp_f32 v25, v25
    s_waitcnt lgkmcnt(1)
    v_mfma_f32_32x32x16_bf16 v[56:71], v[88:91], v[76:79], v[56:71]
    ds_read_b64_tr_b16 v[240:241], v236 offset:0
    ds_read_b64_tr_b16 v[242:243], v237 offset:0
    v_exp_f32 v26, v26
    v_exp_f32 v27, v27
    v_cvt_pk_bf16_f32 v72, v24, v25
    v_exp_f32 v28, v28
    v_exp_f32 v29, v29
    v_mfma_f32_32x32x16_bf16 v[40:55], v[80:83], v[4:7], v[8:23]
    ds_read_b128 v[80:83], v95 offset:46464
    v_cvt_pk_bf16_f32 v73, v26, v27
    v_exp_f32 v30, v30
    v_exp_f32 v31, v31
    s_add_u32 s39, s38, 32768
    buffer_load_dwordx4 v[136:139], v3, s[4:7], s39 offen offset:2048
    v_cvt_pk_bf16_f32 v74, v28, v29
    v_exp_f32 v32, v32
    v_exp_f32 v33, v33
    v_cvt_pk_bf16_f32 v75, v30, v31
    v_exp_f32 v34, v34
    v_exp_f32 v35, v35
    s_waitcnt lgkmcnt(1)
    v_mfma_f32_32x32x16_bf16 v[56:71], v[84:87], v[72:75], v[56:71]
    ds_read_b128 v[88:91], v92 offset:42784
    ds_read_b128 v[84:87], v92 offset:44352
    v_cvt_pk_bf16_f32 v76, v32, v33
    v_exp_f32 v36, v36
    v_exp_f32 v37, v37
    v_cvt_pk_bf16_f32 v77, v34, v35
    v_exp_f32 v38, v38
    v_exp_f32 v39, v39
    v_cvt_pk_bf16_f32 v78, v36, v37
    v_cvt_pk_bf16_f32 v79, v38, v39
    v_exp_f32 v40, v40
    v_exp_f32 v41, v41
    s_waitcnt lgkmcnt(1)
    v_mfma_f32_32x32x16_bf16 v[56:71], v[88:91], v[76:79], v[56:71]
    ds_read_b64_tr_b16 v[244:245], v236 offset:64
    ds_read_b64_tr_b16 v[246:247], v237 offset:64
    v_exp_f32 v42, v42
    v_exp_f32 v43, v43
    v_cvt_pk_bf16_f32 v72, v40, v41
    v_exp_f32 v44, v44
    v_exp_f32 v45, v45
    v_mfma_f32_32x32x16_bf16 v[24:39], v[80:83], v[4:7], v[8:23]
    ds_read_b128 v[80:83], v95 offset:48576
    v_cvt_pk_bf16_f32 v73, v42, v43
    v_exp_f32 v46, v46
    v_exp_f32 v47, v47
    s_add_u32 s39, s38, 49152
    buffer_load_dwordx4 v[140:143], v3, s[4:7], s39 offen offset:2048
    v_cvt_pk_bf16_f32 v74, v44, v45
    v_exp_f32 v48, v48
    v_exp_f32 v49, v49
    v_cvt_pk_bf16_f32 v75, v46, v47
    v_exp_f32 v50, v50
    v_exp_f32 v51, v51
    s_waitcnt lgkmcnt(1)
    v_mfma_f32_32x32x16_bf16 v[56:71], v[84:87], v[72:75], v[56:71]
    ds_read_b128 v[88:91], v92 offset:44896
    ds_read_b128 v[84:87], v92 offset:46464
    v_cvt_pk_bf16_f32 v76, v48, v49
    v_exp_f32 v52, v52
    v_exp_f32 v53, v53
    v_cvt_pk_bf16_f32 v77, v50, v51
    v_exp_f32 v54, v54
    v_exp_f32 v55, v55
    v_cvt_pk_bf16_f32 v78, v52, v53
    v_cvt_pk_bf16_f32 v79, v54, v55
    v_exp_f32 v24, v24
    v_exp_f32 v25, v25
    s_waitcnt lgkmcnt(1)
    v_mfma_f32_32x32x16_bf16 v[56:71], v[88:91], v[76:79], v[56:71]
    ds_read_b64_tr_b16 v[248:249], v236 offset:128
    ds_read_b64_tr_b16 v[250:251], v237 offset:128
    v_exp_f32 v26, v26
    v_exp_f32 v27, v27
    v_cvt_pk_bf16_f32 v72, v24, v25
    v_exp_f32 v28, v28
    v_exp_f32 v29, v29
    v_mfma_f32_32x32x16_bf16 v[40:55], v[80:83], v[4:7], v[8:23]
    ds_read_b128 v[80:83], v95 offset:50688
    v_cvt_pk_bf16_f32 v73, v26, v27
    v_exp_f32 v30, v30
    v_exp_f32 v31, v31
    s_add_u32 s39, s38, 0
    buffer_load_dwordx4 v[144:147], v3, s[4:7], s39 offen offset:3072
    v_cvt_pk_bf16_f32 v74, v28, v29
    v_exp_f32 v32, v32
    v_exp_f32 v33, v33
    v_cvt_pk_bf16_f32 v75, v30, v31
    v_exp_f32 v34, v34
    v_exp_f32 v35, v35
    s_waitcnt lgkmcnt(1)
    v_mfma_f32_32x32x16_bf16 v[56:71], v[84:87], v[72:75], v[56:71]
    ds_read_b128 v[88:91], v92 offset:47008
    ds_read_b128 v[84:87], v92 offset:48576
    v_cvt_pk_bf16_f32 v76, v32, v33
    v_exp_f32 v36, v36
    v_exp_f32 v37, v37
    v_cvt_pk_bf16_f32 v77, v34, v35
    v_exp_f32 v38, v38
    v_exp_f32 v39, v39
    v_cvt_pk_bf16_f32 v78, v36, v37
    v_cvt_pk_bf16_f32 v79, v38, v39
    s_setprio 2
    v_exp_f32 v40, v40
    v_exp_f32 v41, v41
    s_waitcnt lgkmcnt(1)
    v_mfma_f32_32x32x16_bf16 v[56:71], v[88:91], v[76:79], v[56:71]
    ds_read_b64_tr_b16 v[252:253], v236 offset:192
    ds_read_b64_tr_b16 v[254:255], v237 offset:192
    v_exp_f32 v42, v42
    v_exp_f32 v43, v43
    v_cvt_pk_bf16_f32 v72, v40, v41
    v_exp_f32 v44, v44
    v_exp_f32 v45, v45
    v_mfma_f32_32x32x16_bf16 v[24:39], v[80:83], v[4:7], v[8:23]
    ds_read_b128 v[80:83], v95 offset:52800
    v_cvt_pk_bf16_f32 v73, v42, v43
    v_exp_f32 v46, v46
    v_exp_f32 v47, v47
    s_add_u32 s39, s38, 16384
    buffer_load_dwordx4 v[148:151], v3, s[4:7], s39 offen offset:3072
    v_cvt_pk_bf16_f32 v74, v44, v45
    v_exp_f32 v48, v48
    v_exp_f32 v49, v49
    v_cvt_pk_bf16_f32 v75, v46, v47
    v_exp_f32 v50, v50
    v_exp_f32 v51, v51
    s_waitcnt lgkmcnt(1)
    v_mfma_f32_32x32x16_bf16 v[56:71], v[84:87], v[72:75], v[56:71]
    ds_read_b128 v[88:91], v92 offset:49120
    ds_read_b128 v[84:87], v92 offset:50688
    v_cvt_pk_bf16_f32 v76, v48, v49
    v_exp_f32 v52, v52
    v_exp_f32 v53, v53
    v_cvt_pk_bf16_f32 v77, v50, v51
    v_exp_f32 v54, v54
    v_exp_f32 v55, v55
    v_cvt_pk_bf16_f32 v78, v52, v53
    v_cvt_pk_bf16_f32 v79, v54, v55
    v_exp_f32 v24, v24
    v_exp_f32 v25, v25
    s_waitcnt lgkmcnt(1)
    v_mfma_f32_32x32x16_bf16 v[56:71], v[88:91], v[76:79], v[56:71]
    buffer_store_dwordx4 v[240:243], v3, s[4:7], s54 offen sc0 sc1
    s_add_u32 s54, s54, s55
    v_exp_f32 v26, v26
    v_exp_f32 v27, v27
    v_cvt_pk_bf16_f32 v72, v24, v25
    v_exp_f32 v28, v28
    v_exp_f32 v29, v29
    v_mfma_f32_32x32x16_bf16 v[40:55], v[80:83], v[4:7], v[8:23]
    ds_read_b128 v[80:83], v95 offset:54912
    v_cvt_pk_bf16_f32 v73, v26, v27
    v_exp_f32 v30, v30
    v_exp_f32 v31, v31
    s_add_u32 s39, s38, 32768
    buffer_load_dwordx4 v[152:155], v3, s[4:7], s39 offen offset:3072
    v_cvt_pk_bf16_f32 v74, v28, v29
    v_exp_f32 v32, v32
    v_exp_f32 v33, v33
    v_cvt_pk_bf16_f32 v75, v30, v31
    v_exp_f32 v34, v34
    v_exp_f32 v35, v35
    s_waitcnt lgkmcnt(1)
    v_mfma_f32_32x32x16_bf16 v[56:71], v[84:87], v[72:75], v[56:71]
    ds_read_b128 v[88:91], v92 offset:51232
    ds_read_b128 v[84:87], v92 offset:52800
    v_cvt_pk_bf16_f32 v76, v32, v33
    v_exp_f32 v36, v36
    v_exp_f32 v37, v37
    v_cvt_pk_bf16_f32 v77, v34, v35
    v_exp_f32 v38, v38
    v_exp_f32 v39, v39
    v_cvt_pk_bf16_f32 v78, v36, v37
    v_cvt_pk_bf16_f32 v79, v38, v39
    v_exp_f32 v40, v40
    v_exp_f32 v41, v41
    s_waitcnt lgkmcnt(1)
    v_mfma_f32_32x32x16_bf16 v[56:71], v[88:91], v[76:79], v[56:71]
    buffer_store_dwordx4 v[244:247], v3, s[4:7], s54 offen sc0 sc1
    s_add_u32 s54, s54, s55
    v_exp_f32 v42, v42
    v_exp_f32 v43, v43
    v_cvt_pk_bf16_f32 v72, v40, v41
    v_exp_f32 v44, v44
    v_exp_f32 v45, v45
    v_mfma_f32_32x32x16_bf16 v[24:39], v[80:83], v[4:7], v[8:23]
    ds_read_b128 v[80:83], v95 offset:57024
    v_cvt_pk_bf16_f32 v73, v42, v43
    v_exp_f32 v46, v46
    v_exp_f32 v47, v47
    s_add_u32 s39, s38, 49152
    buffer_load_dwordx4 v[156:159], v3, s[4:7], s39 offen offset:3072
    v_cvt_pk_bf16_f32 v74, v44, v45
    v_exp_f32 v48, v48
    v_exp_f32 v49, v49
    v_cvt_pk_bf16_f32 v75, v46, v47
    v_exp_f32 v50, v50
    v_exp_f32 v51, v51
    s_waitcnt lgkmcnt(1)
    v_mfma_f32_32x32x16_bf16 v[56:71], v[84:87], v[72:75], v[56:71]
    ds_read_b128 v[88:91], v92 offset:53344
    ds_read_b128 v[84:87], v92 offset:54912
    v_cvt_pk_bf16_f32 v76, v48, v49
    v_exp_f32 v52, v52
    v_exp_f32 v53, v53
    v_cvt_pk_bf16_f32 v77, v50, v51
    v_exp_f32 v54, v54
    v_exp_f32 v55, v55
    v_cvt_pk_bf16_f32 v78, v52, v53
    v_cvt_pk_bf16_f32 v79, v54, v55
    s_setprio 1
    v_exp_f32 v24, v24
    v_exp_f32 v25, v25
    s_waitcnt lgkmcnt(1)
    v_mfma_f32_32x32x16_bf16 v[56:71], v[88:91], v[76:79], v[56:71]
    buffer_store_dwordx4 v[248:251], v3, s[4:7], s54 offen sc0 sc1
    s_add_u32 s54, s54, s55
    v_exp_f32 v26, v26
    v_exp_f32 v27, v27
    v_cvt_pk_bf16_f32 v72, v24, v25
    v_exp_f32 v28, v28
    v_exp_f32 v29, v29
    v_mfma_f32_32x32x16_bf16 v[40:55], v[80:83], v[4:7], v[8:23]
    ds_read_b128 v[80:83], v95 offset:59136
    v_cvt_pk_bf16_f32 v73, v26, v27
    v_exp_f32 v30, v30
    v_exp_f32 v31, v31
    s_add_u32 s39, s38, 4096
    buffer_load_dwordx4 v[160:163], v3, s[4:7], s39 offen offset:0
    v_cvt_pk_bf16_f32 v74, v28, v29
    v_exp_f32 v32, v32
    v_exp_f32 v33, v33
    v_cvt_pk_bf16_f32 v75, v30, v31
    v_exp_f32 v34, v34
    v_exp_f32 v35, v35
    s_waitcnt lgkmcnt(1)
    v_mfma_f32_32x32x16_bf16 v[56:71], v[84:87], v[72:75], v[56:71]
    ds_read_b128 v[88:91], v92 offset:55456
    ds_read_b128 v[84:87], v92 offset:57024
    v_cvt_pk_bf16_f32 v76, v32, v33
    v_exp_f32 v36, v36
    v_exp_f32 v37, v37
    v_cvt_pk_bf16_f32 v77, v34, v35
    v_exp_f32 v38, v38
    v_exp_f32 v39, v39
    v_cvt_pk_bf16_f32 v78, v36, v37
    v_cvt_pk_bf16_f32 v79, v38, v39
    v_exp_f32 v40, v40
    v_exp_f32 v41, v41
    s_waitcnt lgkmcnt(1)
    v_mfma_f32_32x32x16_bf16 v[56:71], v[88:91], v[76:79], v[56:71]
    buffer_store_dwordx4 v[252:255], v3, s[4:7], s54 offen sc0 sc1
    s_add_u32 s54, s54, s55
    v_exp_f32 v42, v42
    v_exp_f32 v43, v43
    v_cvt_pk_bf16_f32 v72, v40, v41
    v_exp_f32 v44, v44
    v_exp_f32 v45, v45
    v_mfma_f32_32x32x16_bf16 v[24:39], v[80:83], v[4:7], v[8:23]
    ds_read_b128 v[80:83], v95 offset:61248
    v_cvt_pk_bf16_f32 v73, v42, v43
    v_exp_f32 v46, v46
    v_exp_f32 v47, v47
    s_add_u32 s39, s38, 20480
    buffer_load_dwordx4 v[164:167], v3, s[4:7], s39 offen offset:0
    v_cvt_pk_bf16_f32 v74, v44, v45
    v_exp_f32 v48, v48
    v_exp_f32 v49, v49
    v_cvt_pk_bf16_f32 v75, v46, v47
    v_exp_f32 v50, v50
    v_exp_f32 v51, v51
    s_waitcnt lgkmcnt(1)
    v_mfma_f32_32x32x16_bf16 v[56:71], v[84:87], v[72:75], v[56:71]
    ds_read_b128 v[88:91], v92 offset:57568
    ds_read_b128 v[84:87], v92 offset:59136
    v_cvt_pk_bf16_f32 v76, v48, v49
    v_exp_f32 v52, v52
    v_exp_f32 v53, v53
    v_cvt_pk_bf16_f32 v77, v50, v51
    v_exp_f32 v54, v54
    v_exp_f32 v55, v55
    v_cvt_pk_bf16_f32 v78, v52, v53
    v_cvt_pk_bf16_f32 v79, v54, v55
    v_exp_f32 v24, v24
    v_exp_f32 v25, v25
    s_waitcnt lgkmcnt(1)
    v_mfma_f32_32x32x16_bf16 v[56:71], v[88:91], v[76:79], v[56:71]
    v_exp_f32 v26, v26
    v_exp_f32 v27, v27
    v_cvt_pk_bf16_f32 v72, v24, v25
    v_exp_f32 v28, v28
    v_exp_f32 v29, v29
    v_mfma_f32_32x32x16_bf16 v[40:55], v[80:83], v[4:7], v[8:23]
    ds_read_b128 v[80:83], v95 offset:63360
    v_cvt_pk_bf16_f32 v73, v26, v27
    v_exp_f32 v30, v30
    v_exp_f32 v31, v31
    s_add_u32 s39, s38, 36864
    buffer_load_dwordx4 v[168:171], v3, s[4:7], s39 offen offset:0
    v_cvt_pk_bf16_f32 v74, v28, v29
    v_exp_f32 v32, v32
    v_exp_f32 v33, v33
    v_cvt_pk_bf16_f32 v75, v30, v31
    v_exp_f32 v34, v34
    v_exp_f32 v35, v35
    s_waitcnt lgkmcnt(1)
    v_mfma_f32_32x32x16_bf16 v[56:71], v[84:87], v[72:75], v[56:71]
    ds_read_b128 v[88:91], v92 offset:59680
    ds_read_b128 v[84:87], v92 offset:61248
    v_cvt_pk_bf16_f32 v76, v32, v33
    v_exp_f32 v36, v36
    v_exp_f32 v37, v37
    v_cvt_pk_bf16_f32 v77, v34, v35
    v_exp_f32 v38, v38
    v_exp_f32 v39, v39
    v_cvt_pk_bf16_f32 v78, v36, v37
    v_cvt_pk_bf16_f32 v79, v38, v39
    s_setprio 0
    v_exp_f32 v40, v40
    v_exp_f32 v41, v41
    s_waitcnt lgkmcnt(1)
    v_mfma_f32_32x32x16_bf16 v[56:71], v[88:91], v[76:79], v[56:71]
    v_exp_f32 v42, v42
    v_exp_f32 v43, v43
    v_cvt_pk_bf16_f32 v72, v40, v41
    v_exp_f32 v44, v44
    v_exp_f32 v45, v45
    v_mfma_f32_32x32x16_bf16 v[24:39], v[80:83], v[4:7], v[8:23]
    v_add_u32 v95, 63360, v95
    ds_read_b128 v[80:83], v95 offset:2112
    v_cvt_pk_bf16_f32 v73, v42, v43
    v_exp_f32 v46, v46
    v_exp_f32 v47, v47
    s_add_u32 s39, s38, 53248
    buffer_load_dwordx4 v[172:175], v3, s[4:7], s39 offen offset:0
    v_cvt_pk_bf16_f32 v74, v44, v45
    v_exp_f32 v48, v48
    v_exp_f32 v49, v49
    v_cvt_pk_bf16_f32 v75, v46, v47
    v_exp_f32 v50, v50
    v_exp_f32 v51, v51
    s_waitcnt lgkmcnt(1)
    v_mfma_f32_32x32x16_bf16 v[56:71], v[84:87], v[72:75], v[56:71]
    ds_read_b128 v[88:91], v92 offset:61792
    ds_read_b128 v[84:87], v92 offset:63360
    v_cvt_pk_bf16_f32 v76, v48, v49
    v_exp_f32 v52, v52
    v_exp_f32 v53, v53
    v_cvt_pk_bf16_f32 v77, v50, v51
    v_exp_f32 v54, v54
    v_exp_f32 v55, v55
    v_cvt_pk_bf16_f32 v78, v52, v53
    v_cvt_pk_bf16_f32 v79, v54, v55
    v_exp_f32 v24, v24
    v_exp_f32 v25, v25
    s_waitcnt lgkmcnt(1)
    v_mfma_f32_32x32x16_bf16 v[56:71], v[88:91], v[76:79], v[56:71]
    v_exp_f32 v26, v26
    v_exp_f32 v27, v27
    v_cvt_pk_bf16_f32 v72, v24, v25
    v_exp_f32 v28, v28
    v_exp_f32 v29, v29
    v_mfma_f32_32x32x16_bf16 v[40:55], v[80:83], v[4:7], v[8:23]
    ds_read_b128 v[80:83], v95 offset:4224
    v_cvt_pk_bf16_f32 v73, v26, v27
    v_exp_f32 v30, v30
    v_exp_f32 v31, v31
    s_add_u32 s39, s38, 4096
    buffer_load_dwordx4 v[176:179], v3, s[4:7], s39 offen offset:1024
    v_cvt_pk_bf16_f32 v74, v28, v29
    v_exp_f32 v32, v32
    v_exp_f32 v33, v33
    v_cvt_pk_bf16_f32 v75, v30, v31
    v_exp_f32 v34, v34
    v_exp_f32 v35, v35
    s_waitcnt lgkmcnt(1)
    v_mfma_f32_32x32x16_bf16 v[56:71], v[84:87], v[72:75], v[56:71]
    ds_read_b128 v[88:91], v92 offset:63904
    v_add_u32 v92, 63360, v92
    ds_read_b128 v[84:87], v92 offset:2112
    v_cvt_pk_bf16_f32 v76, v32, v33
    v_exp_f32 v36, v36
    v_exp_f32 v37, v37
    v_cvt_pk_bf16_f32 v77, v34, v35
    v_exp_f32 v38, v38
    v_exp_f32 v39, v39
    v_cvt_pk_bf16_f32 v78, v36, v37
    v_cvt_pk_bf16_f32 v79, v38, v39
    v_exp_f32 v40, v40
    v_exp_f32 v41, v41
    s_waitcnt lgkmcnt(1)
    v_mfma_f32_32x32x16_bf16 v[56:71], v[88:91], v[76:79], v[56:71]
    v_exp_f32 v42, v42
    v_exp_f32 v43, v43
    v_cvt_pk_bf16_f32 v72, v40, v41
    v_exp_f32 v44, v44
    v_exp_f32 v45, v45
    v_mfma_f32_32x32x16_bf16 v[24:39], v[80:83], v[4:7], v[8:23]
    ds_read_b128 v[80:83], v95 offset:6336
    v_cvt_pk_bf16_f32 v73, v42, v43
    v_exp_f32 v46, v46
    v_exp_f32 v47, v47
    s_add_u32 s39, s38, 20480
    buffer_load_dwordx4 v[180:183], v3, s[4:7], s39 offen offset:1024
    v_cvt_pk_bf16_f32 v74, v44, v45
    v_exp_f32 v48, v48
    v_exp_f32 v49, v49
    v_cvt_pk_bf16_f32 v75, v46, v47
    v_exp_f32 v50, v50
    v_exp_f32 v51, v51
    s_waitcnt lgkmcnt(1)
    v_mfma_f32_32x32x16_bf16 v[56:71], v[84:87], v[72:75], v[56:71]
    ds_read_b128 v[88:91], v92 offset:2656
    ds_read_b128 v[84:87], v92 offset:4224
    v_cvt_pk_bf16_f32 v76, v48, v49
    v_exp_f32 v52, v52
    v_exp_f32 v53, v53
    v_cvt_pk_bf16_f32 v77, v50, v51
    v_exp_f32 v54, v54
    v_exp_f32 v55, v55
    v_cvt_pk_bf16_f32 v78, v52, v53
    v_cvt_pk_bf16_f32 v79, v54, v55
    s_waitcnt lgkmcnt(1) vmcnt(5)
    s_barrier
    s_cmp_eq_u32 s3, 0
    s_cselect_b64 exec, 1, 0
    s_and_b32 s56, s2, 15
    s_lshl_b32 s56, s56, 7
    s_add_u32 s56, s56, 0x18000
    v_mov_b32 v93, 1
    buffer_atomic_add v93, v1, s[4:7], s56 offen sc1
    s_mov_b64 exec, -1
    s_setprio 3
    v_exp_f32 v24, v24
    v_exp_f32 v25, v25
    s_waitcnt lgkmcnt(1)
    v_mfma_f32_32x32x16_bf16 v[56:71], v[88:91], v[76:79], v[56:71]
    s_add_u32 m0, s27, 106496
    s_add_u32 s28, s28, 8192
    buffer_load_dwordx4 v3, s[4:7], s28 offen lds
    v_exp_f32 v26, v26
    v_exp_f32 v27, v27
    v_cvt_pk_bf16_f32 v72, v24, v25
    v_exp_f32 v28, v28
    v_exp_f32 v29, v29
    v_mfma_f32_32x32x16_bf16 v[40:55], v[80:83], v[4:7], v[8:23]
    ds_read_b128 v[80:83], v95 offset:8448
    v_cvt_pk_bf16_f32 v73, v26, v27
    v_exp_f32 v30, v30
    v_exp_f32 v31, v31
    s_add_u32 s39, s38, 36864
    buffer_load_dwordx4 v[184:187], v3, s[4:7], s39 offen offset:1024
    v_cvt_pk_bf16_f32 v74, v28, v29
    v_exp_f32 v32, v32
    v_exp_f32 v33, v33
    v_cvt_pk_bf16_f32 v75, v30, v31
    v_exp_f32 v34, v34
    v_exp_f32 v35, v35
    s_waitcnt lgkmcnt(1)
    v_mfma_f32_32x32x16_bf16 v[56:71], v[84:87], v[72:75], v[56:71]
    ds_read_b128 v[88:91], v92 offset:4768
    ds_read_b128 v[84:87], v92 offset:6336
    v_cvt_pk_bf16_f32 v76, v32, v33
    v_exp_f32 v36, v36
    v_exp_f32 v37, v37
    v_cvt_pk_bf16_f32 v77, v34, v35
    v_exp_f32 v38, v38
    v_exp_f32 v39, v39
    v_cvt_pk_bf16_f32 v78, v36, v37
    v_cvt_pk_bf16_f32 v79, v38, v39
    v_exp_f32 v40, v40
    v_exp_f32 v41, v41
    s_waitcnt lgkmcnt(1)
    v_mfma_f32_32x32x16_bf16 v[56:71], v[88:91], v[76:79], v[56:71]
    s_add_u32 m0, s27, 114688
    s_add_u32 s28, s28, 8192
    buffer_load_dwordx4 v3, s[4:7], s28 offen lds
    v_exp_f32 v42, v42
    v_exp_f32 v43, v43
    v_cvt_pk_bf16_f32 v72, v40, v41
    v_exp_f32 v44, v44
    v_exp_f32 v45, v45
    v_mfma_f32_32x32x16_bf16 v[24:39], v[80:83], v[4:7], v[8:23]
    ds_read_b128 v[80:83], v95 offset:10560
    v_cvt_pk_bf16_f32 v73, v42, v43
    v_exp_f32 v46, v46
    v_exp_f32 v47, v47
    s_add_u32 s39, s38, 53248
    buffer_load_dwordx4 v[188:191], v3, s[4:7], s39 offen offset:1024
    v_cvt_pk_bf16_f32 v74, v44, v45
    v_exp_f32 v48, v48
    v_exp_f32 v49, v49
    v_cvt_pk_bf16_f32 v75, v46, v47
    v_exp_f32 v50, v50
    v_exp_f32 v51, v51
    s_waitcnt lgkmcnt(1)
    v_mfma_f32_32x32x16_bf16 v[56:71], v[84:87], v[72:75], v[56:71]
    ds_read_b128 v[88:91], v92 offset:6880
    ds_read_b128 v[84:87], v92 offset:8448
    v_cvt_pk_bf16_f32 v76, v48, v49
    v_exp_f32 v52, v52
    v_exp_f32 v53, v53
    v_cvt_pk_bf16_f32 v77, v50, v51
    v_exp_f32 v54, v54
    v_exp_f32 v55, v55
    v_cvt_pk_bf16_f32 v78, v52, v53
    v_cvt_pk_bf16_f32 v79, v54, v55
    v_exp_f32 v24, v24
    v_exp_f32 v25, v25
    s_waitcnt lgkmcnt(1)
    v_mfma_f32_32x32x16_bf16 v[56:71], v[88:91], v[76:79], v[56:71]
    s_add_u32 m0, s27, 122880
    s_add_u32 s28, s28, 8192
    buffer_load_dwordx4 v3, s[4:7], s28 offen lds
    v_exp_f32 v26, v26
    v_exp_f32 v27, v27
    v_cvt_pk_bf16_f32 v72, v24, v25
    v_exp_f32 v28, v28
    v_exp_f32 v29, v29
    v_mfma_f32_32x32x16_bf16 v[40:55], v[80:83], v[4:7], v[8:23]
    ds_read_b128 v[80:83], v95 offset:12672
    v_cvt_pk_bf16_f32 v73, v26, v27
    v_exp_f32 v30, v30
    v_exp_f32 v31, v31
    s_add_u32 s39, s38, 4096
    buffer_load_dwordx4 v[192:195], v3, s[4:7], s39 offen offset:2048
    v_cvt_pk_bf16_f32 v74, v28, v29
    v_exp_f32 v32, v32
    v_exp_f32 v33, v33
    v_cvt_pk_bf16_f32 v75, v30, v31
    v_exp_f32 v34, v34
    v_exp_f32 v35, v35
    s_waitcnt lgkmcnt(1)
    v_mfma_f32_32x32x16_bf16 v[56:71], v[84:87], v[72:75], v[56:71]
    ds_read_b128 v[88:91], v92 offset:8992
    ds_read_b128 v[84:87], v92 offset:10560
    v_cvt_pk_bf16_f32 v76, v32, v33
    v_exp_f32 v36, v36
    v_exp_f32 v37, v37
    v_cvt_pk_bf16_f32 v77, v34, v35
    v_exp_f32 v38, v38
    v_exp_f32 v39, v39
    v_cvt_pk_bf16_f32 v78, v36, v37
    v_cvt_pk_bf16_f32 v79, v38, v39
    v_exp_f32 v40, v40
    v_exp_f32 v41, v41
    s_waitcnt lgkmcnt(1)
    v_mfma_f32_32x32x16_bf16 v[56:71], v[88:91], v[76:79], v[56:71]
    s_add_u32 m0, s27, 131072
    s_add_u32 s28, s28, 8192
    buffer_load_dwordx4 v3, s[4:7], s28 offen lds
    v_exp_f32 v42, v42
    v_exp_f32 v43, v43
    v_cvt_pk_bf16_f32 v72, v40, v41
    v_exp_f32 v44, v44
    v_exp_f32 v45, v45
    v_mfma_f32_32x32x16_bf16 v[24:39], v[80:83], v[4:7], v[8:23]
    ds_read_b128 v[80:83], v95 offset:14784
    v_cvt_pk_bf16_f32 v73, v42, v43
    v_exp_f32 v46, v46
    v_exp_f32 v47, v47
    s_add_u32 s39, s38, 20480
    buffer_load_dwordx4 v[196:199], v3, s[4:7], s39 offen offset:2048
    v_cvt_pk_bf16_f32 v74, v44, v45
    v_exp_f32 v48, v48
    v_exp_f32 v49, v49
    v_cvt_pk_bf16_f32 v75, v46, v47
    v_exp_f32 v50, v50
    v_exp_f32 v51, v51
    s_waitcnt lgkmcnt(1)
    v_mfma_f32_32x32x16_bf16 v[56:71], v[84:87], v[72:75], v[56:71]
    ds_read_b128 v[88:91], v92 offset:11104
    ds_read_b128 v[84:87], v92 offset:12672
    v_cvt_pk_bf16_f32 v76, v48, v49
    v_exp_f32 v52, v52
    v_exp_f32 v53, v53
    v_cvt_pk_bf16_f32 v77, v50, v51
    v_exp_f32 v54, v54
    v_exp_f32 v55, v55
    v_cvt_pk_bf16_f32 v78, v52, v53
    v_cvt_pk_bf16_f32 v79, v54, v55
    s_setprio 2
    v_exp_f32 v24, v24
    v_exp_f32 v25, v25
    s_waitcnt lgkmcnt(1)
    v_mfma_f32_32x32x16_bf16 v[56:71], v[88:91], v[76:79], v[56:71]
    s_add_u32 m0, s40, 0
    s_add_u32 s39, s38, 10240
    buffer_load_dwordx4 v3, s[4:7], s39 offen lds
    v_exp_f32 v26, v26
    v_exp_f32 v27, v27
    v_cvt_pk_bf16_f32 v72, v24, v25
    v_exp_f32 v28, v28
    v_exp_f32 v29, v29
    v_mfma_f32_32x32x16_bf16 v[40:55], v[80:83], v[4:7], v[8:23]
    ds_read_b128 v[80:83], v95 offset:16896
    v_cvt_pk_bf16_f32 v73, v26, v27
    v_exp_f32 v30, v30
    v_exp_f32 v31, v31
    s_add_u32 s39, s38, 36864
    buffer_load_dwordx4 v[200:203], v3, s[4:7], s39 offen offset:2048
    v_cvt_pk_bf16_f32 v74, v28, v29
    v_exp_f32 v32, v32
    v_exp_f32 v33, v33
    v_cvt_pk_bf16_f32 v75, v30, v31
    v_exp_f32 v34, v34
    v_exp_f32 v35, v35
    s_waitcnt lgkmcnt(1)
    v_mfma_f32_32x32x16_bf16 v[56:71], v[84:87], v[72:75], v[56:71]
    ds_read_b128 v[88:91], v92 offset:13216
    ds_read_b128 v[84:87], v92 offset:14784
    v_cvt_pk_bf16_f32 v76, v32, v33
    v_exp_f32 v36, v36
    v_exp_f32 v37, v37
    v_cvt_pk_bf16_f32 v77, v34, v35
    v_exp_f32 v38, v38
    v_exp_f32 v39, v39
    v_cvt_pk_bf16_f32 v78, v36, v37
    v_cvt_pk_bf16_f32 v79, v38, v39
    v_exp_f32 v40, v40
    v_exp_f32 v41, v41
    s_waitcnt lgkmcnt(1)
    v_mfma_f32_32x32x16_bf16 v[56:71], v[88:91], v[76:79], v[56:71]
    s_add_u32 m0, s40, 1024
    s_add_u32 s39, s38, 26624
    buffer_load_dwordx4 v3, s[4:7], s39 offen lds
    v_exp_f32 v42, v42
    v_exp_f32 v43, v43
    v_cvt_pk_bf16_f32 v72, v40, v41
    v_exp_f32 v44, v44
    v_exp_f32 v45, v45
    v_mfma_f32_32x32x16_bf16 v[24:39], v[80:83], v[4:7], v[8:23]
    ds_read_b128 v[80:83], v95 offset:19008
    v_cvt_pk_bf16_f32 v73, v42, v43
    v_exp_f32 v46, v46
    v_exp_f32 v47, v47
    s_add_u32 s39, s38, 53248
    buffer_load_dwordx4 v[204:207], v3, s[4:7], s39 offen offset:2048
    v_cvt_pk_bf16_f32 v74, v44, v45
    v_exp_f32 v48, v48
    v_exp_f32 v49, v49
    v_cvt_pk_bf16_f32 v75, v46, v47
    v_exp_f32 v50, v50
    v_exp_f32 v51, v51
    s_waitcnt lgkmcnt(1)
    v_mfma_f32_32x32x16_bf16 v[56:71], v[84:87], v[72:75], v[56:71]
    ds_read_b128 v[88:91], v92 offset:15328
    ds_read_b128 v[84:87], v92 offset:16896
    v_cvt_pk_bf16_f32 v76, v48, v49
    v_exp_f32 v52, v52
    v_exp_f32 v53, v53
    v_cvt_pk_bf16_f32 v77, v50, v51
    v_exp_f32 v54, v54
    v_exp_f32 v55, v55
    v_cvt_pk_bf16_f32 v78, v52, v53
    v_cvt_pk_bf16_f32 v79, v54, v55
    v_exp_f32 v24, v24
    v_exp_f32 v25, v25
    s_waitcnt lgkmcnt(1)
    v_mfma_f32_32x32x16_bf16 v[56:71], v[88:91], v[76:79], v[56:71]
    s_add_u32 m0, s40, 2048
    s_add_u32 s39, s38, 43008
    buffer_load_dwordx4 v3, s[4:7], s39 offen lds
    v_exp_f32 v26, v26
    v_exp_f32 v27, v27
    v_cvt_pk_bf16_f32 v72, v24, v25
    v_exp_f32 v28, v28
    v_exp_f32 v29, v29
    v_mfma_f32_32x32x16_bf16 v[40:55], v[80:83], v[4:7], v[8:23]
    ds_read_b128 v[80:83], v95 offset:21120
    v_cvt_pk_bf16_f32 v73, v26, v27
    v_exp_f32 v30, v30
    v_exp_f32 v31, v31
    s_add_u32 s39, s38, 4096
    buffer_load_dwordx4 v[208:211], v3, s[4:7], s39 offen offset:3072
    v_cvt_pk_bf16_f32 v74, v28, v29
    v_exp_f32 v32, v32
    v_exp_f32 v33, v33
    v_cvt_pk_bf16_f32 v75, v30, v31
    v_exp_f32 v34, v34
    v_exp_f32 v35, v35
    s_waitcnt lgkmcnt(1)
    v_mfma_f32_32x32x16_bf16 v[56:71], v[84:87], v[72:75], v[56:71]
    ds_read_b128 v[88:91], v92 offset:17440
    ds_read_b128 v[84:87], v92 offset:19008
    v_cvt_pk_bf16_f32 v76, v32, v33
    v_exp_f32 v36, v36
    v_exp_f32 v37, v37
    v_cvt_pk_bf16_f32 v77, v34, v35
    v_exp_f32 v38, v38
    v_exp_f32 v39, v39
    v_cvt_pk_bf16_f32 v78, v36, v37
    v_cvt_pk_bf16_f32 v79, v38, v39
    v_exp_f32 v40, v40
    v_exp_f32 v41, v41
    s_waitcnt lgkmcnt(1)
    v_mfma_f32_32x32x16_bf16 v[56:71], v[88:91], v[76:79], v[56:71]
    s_add_u32 m0, s40, 3072
    s_add_u32 s39, s38, 59392
    buffer_load_dwordx4 v3, s[4:7], s39 offen lds
    v_exp_f32 v42, v42
    v_exp_f32 v43, v43
    v_cvt_pk_bf16_f32 v72, v40, v41
    v_exp_f32 v44, v44
    v_exp_f32 v45, v45
    v_mfma_f32_32x32x16_bf16 v[24:39], v[80:83], v[4:7], v[8:23]
    ds_read_b128 v[80:83], v95 offset:23232
    v_cvt_pk_bf16_f32 v73, v42, v43
    v_exp_f32 v46, v46
    v_exp_f32 v47, v47
    s_add_u32 s39, s38, 20480
    buffer_load_dwordx4 v[212:215], v3, s[4:7], s39 offen offset:3072
    v_cvt_pk_bf16_f32 v74, v44, v45
    v_exp_f32 v48, v48
    v_exp_f32 v49, v49
    v_cvt_pk_bf16_f32 v75, v46, v47
    v_exp_f32 v50, v50
    v_exp_f32 v51, v51
    s_waitcnt lgkmcnt(1)
    v_mfma_f32_32x32x16_bf16 v[56:71], v[84:87], v[72:75], v[56:71]
    ds_read_b128 v[88:91], v92 offset:19552
    ds_read_b128 v[84:87], v92 offset:21120
    v_cvt_pk_bf16_f32 v76, v48, v49
    v_exp_f32 v52, v52
    v_exp_f32 v53, v53
    v_cvt_pk_bf16_f32 v77, v50, v51
    v_exp_f32 v54, v54
    v_exp_f32 v55, v55
    v_cvt_pk_bf16_f32 v78, v52, v53
    v_cvt_pk_bf16_f32 v79, v54, v55
    s_setprio 1
    v_exp_f32 v24, v24
    v_exp_f32 v25, v25
    s_waitcnt lgkmcnt(1)
    v_mfma_f32_32x32x16_bf16 v[56:71], v[88:91], v[76:79], v[56:71]
    s_add_u32 m0, s40, 32768
    s_add_u32 s39, s38, 11264
    buffer_load_dwordx4 v3, s[4:7], s39 offen lds
    v_exp_f32 v26, v26
    v_exp_f32 v27, v27
    v_cvt_pk_bf16_f32 v72, v24, v25
    v_exp_f32 v28, v28
    v_exp_f32 v29, v29
    v_mfma_f32_32x32x16_bf16 v[40:55], v[80:83], v[4:7], v[8:23]
    ds_read_b128 v[80:83], v95 offset:25344
    v_cvt_pk_bf16_f32 v73, v26, v27
    v_exp_f32 v30, v30
    v_exp_f32 v31, v31
    s_add_u32 s39, s38, 36864
    buffer_load_dwordx4 v[216:219], v3, s[4:7], s39 offen offset:3072
    v_cvt_pk_bf16_f32 v74, v28, v29
    v_exp_f32 v32, v32
    v_exp_f32 v33, v33
    v_cvt_pk_bf16_f32 v75, v30, v31
    v_exp_f32 v34, v34
    v_exp_f32 v35, v35
    s_waitcnt lgkmcnt(1)
    v_mfma_f32_32x32x16_bf16 v[56:71], v[84:87], v[72:75], v[56:71]
    ds_read_b128 v[88:91], v92 offset:21664
    ds_read_b128 v[84:87], v92 offset:23232
    v_cvt_pk_bf16_f32 v76, v32, v33
    v_exp_f32 v36, v36
    v_exp_f32 v37, v37
    v_cvt_pk_bf16_f32 v77, v34, v35
    v_exp_f32 v38, v38
    v_exp_f32 v39, v39
    v_cvt_pk_bf16_f32 v78, v36, v37
    v_cvt_pk_bf16_f32 v79, v38, v39
    v_exp_f32 v40, v40
    v_exp_f32 v41, v41
    s_waitcnt lgkmcnt(1)
    v_mfma_f32_32x32x16_bf16 v[56:71], v[88:91], v[76:79], v[56:71]
    s_add_u32 m0, s40, 33792
    s_add_u32 s39, s38, 27648
    buffer_load_dwordx4 v3, s[4:7], s39 offen lds
    v_exp_f32 v42, v42
    v_exp_f32 v43, v43
    v_cvt_pk_bf16_f32 v72, v40, v41
    v_exp_f32 v44, v44
    v_exp_f32 v45, v45
    v_mfma_f32_32x32x16_bf16 v[24:39], v[80:83], v[4:7], v[8:23]
    ds_read_b128 v[80:83], v95 offset:27456
    v_cvt_pk_bf16_f32 v73, v42, v43
    v_exp_f32 v46, v46
    v_exp_f32 v47, v47
    s_add_u32 s39, s38, 53248
    buffer_load_dwordx4 v[220:223], v3, s[4:7], s39 offen offset:3072
    v_cvt_pk_bf16_f32 v74, v44, v45
    v_exp_f32 v48, v48
    v_exp_f32 v49, v49
    v_cvt_pk_bf16_f32 v75, v46, v47
    v_exp_f32 v50, v50
    v_exp_f32 v51, v51
    s_waitcnt lgkmcnt(1)
    v_mfma_f32_32x32x16_bf16 v[56:71], v[84:87], v[72:75], v[56:71]
    ds_read_b128 v[88:91], v92 offset:23776
    ds_read_b128 v[84:87], v92 offset:25344
    v_cvt_pk_bf16_f32 v76, v48, v49
    v_exp_f32 v52, v52
    v_exp_f32 v53, v53
    v_cvt_pk_bf16_f32 v77, v50, v51
    v_exp_f32 v54, v54
    v_exp_f32 v55, v55
    v_cvt_pk_bf16_f32 v78, v52, v53
    v_cvt_pk_bf16_f32 v79, v54, v55
    v_exp_f32 v24, v24
    v_exp_f32 v25, v25
    s_waitcnt lgkmcnt(1)
    v_mfma_f32_32x32x16_bf16 v[56:71], v[88:91], v[76:79], v[56:71]
    s_add_u32 m0, s40, 34816
    s_add_u32 s39, s38, 44032
    buffer_load_dwordx4 v3, s[4:7], s39 offen lds
    v_exp_f32 v26, v26
    v_exp_f32 v27, v27
    v_cvt_pk_bf16_f32 v72, v24, v25
    v_exp_f32 v28, v28
    v_exp_f32 v29, v29
    v_mfma_f32_32x32x16_bf16 v[40:55], v[80:83], v[4:7], v[8:23]
    ds_read_b128 v[80:83], v95 offset:29568
    v_cvt_pk_bf16_f32 v73, v26, v27
    v_exp_f32 v30, v30
    v_exp_f32 v31, v31
    s_add_u32 s39, s38, 8192
    buffer_load_dwordx4 v[224:227], v3, s[4:7], s39 offen offset:0
    v_cvt_pk_bf16_f32 v74, v28, v29
    v_exp_f32 v32, v32
    v_exp_f32 v33, v33
    v_cvt_pk_bf16_f32 v75, v30, v31
    v_exp_f32 v34, v34
    v_exp_f32 v35, v35
    s_waitcnt lgkmcnt(1)
    v_mfma_f32_32x32x16_bf16 v[56:71], v[84:87], v[72:75], v[56:71]
    ds_read_b128 v[88:91], v92 offset:25888
    ds_read_b128 v[84:87], v92 offset:27456
    v_cvt_pk_bf16_f32 v76, v32, v33
    v_exp_f32 v36, v36
    v_exp_f32 v37, v37
    v_cvt_pk_bf16_f32 v77, v34, v35
    v_exp_f32 v38, v38
    v_exp_f32 v39, v39
    v_cvt_pk_bf16_f32 v78, v36, v37
    v_cvt_pk_bf16_f32 v79, v38, v39
    v_exp_f32 v40, v40
    v_exp_f32 v41, v41
    s_waitcnt lgkmcnt(1)
    v_mfma_f32_32x32x16_bf16 v[56:71], v[88:91], v[76:79], v[56:71]
    s_add_u32 m0, s40, 35840
    s_add_u32 s39, s38, 60416
    buffer_load_dwordx4 v3, s[4:7], s39 offen lds
    v_exp_f32 v42, v42
    v_exp_f32 v43, v43
    v_cvt_pk_bf16_f32 v72, v40, v41
    v_exp_f32 v44, v44
    v_exp_f32 v45, v45
    v_mfma_f32_32x32x16_bf16 v[24:39], v[80:83], v[4:7], v[8:23]
    ds_read_b128 v[80:83], v95 offset:31680
    v_cvt_pk_bf16_f32 v73, v42, v43
    v_exp_f32 v46, v46
    v_exp_f32 v47, v47
    s_add_u32 s39, s38, 24576
    buffer_load_dwordx4 v[228:231], v3, s[4:7], s39 offen offset:0
    v_cvt_pk_bf16_f32 v74, v44, v45
    v_exp_f32 v48, v48
    v_exp_f32 v49, v49
    v_cvt_pk_bf16_f32 v75, v46, v47
    v_exp_f32 v50, v50
    v_exp_f32 v51, v51
    s_waitcnt lgkmcnt(1)
    v_mfma_f32_32x32x16_bf16 v[56:71], v[84:87], v[72:75], v[56:71]
    ds_read_b128 v[88:91], v92 offset:28000
    ds_read_b128 v[84:87], v92 offset:29568
    v_cvt_pk_bf16_f32 v76, v48, v49
    v_exp_f32 v52, v52
    v_exp_f32 v53, v53
    v_cvt_pk_bf16_f32 v77, v50, v51
    v_exp_f32 v54, v54
    v_exp_f32 v55, v55
    v_cvt_pk_bf16_f32 v78, v52, v53
    v_cvt_pk_bf16_f32 v79, v54, v55
    s_setprio 0
    v_exp_f32 v24, v24
    v_exp_f32 v25, v25
    s_waitcnt lgkmcnt(1)
    v_mfma_f32_32x32x16_bf16 v[56:71], v[88:91], v[76:79], v[56:71]
    v_exp_f32 v26, v26
    v_exp_f32 v27, v27
    v_cvt_pk_bf16_f32 v72, v24, v25
    v_exp_f32 v28, v28
    v_exp_f32 v29, v29
    v_mfma_f32_32x32x16_bf16 v[40:55], v[80:83], v[4:7], v[8:23]
    ds_read_b128 v[80:83], v95 offset:33792
    v_cvt_pk_bf16_f32 v73, v26, v27
    v_exp_f32 v30, v30
    v_exp_f32 v31, v31
    s_add_u32 s39, s38, 40960
    buffer_load_dwordx4 v[232:235], v3, s[4:7], s39 offen offset:0
    v_cvt_pk_bf16_f32 v74, v28, v29
    v_exp_f32 v32, v32
    v_exp_f32 v33, v33
    v_cvt_pk_bf16_f32 v75, v30, v31
    v_exp_f32 v34, v34
    v_exp_f32 v35, v35
    s_waitcnt lgkmcnt(1)
    v_mfma_f32_32x32x16_bf16 v[56:71], v[84:87], v[72:75], v[56:71]
    ds_read_b128 v[88:91], v92 offset:30112
    ds_read_b128 v[84:87], v92 offset:31680
    v_cvt_pk_bf16_f32 v76, v32, v33
    v_exp_f32 v36, v36
    v_exp_f32 v37, v37
    v_cvt_pk_bf16_f32 v77, v34, v35
    v_exp_f32 v38, v38
    v_exp_f32 v39, v39
    v_cvt_pk_bf16_f32 v78, v36, v37
    v_cvt_pk_bf16_f32 v79, v38, v39
    v_exp_f32 v40, v40
    v_exp_f32 v41, v41
    s_waitcnt lgkmcnt(1)
    v_mfma_f32_32x32x16_bf16 v[56:71], v[88:91], v[76:79], v[56:71]
    v_exp_f32 v42, v42
    v_exp_f32 v43, v43
    v_cvt_pk_bf16_f32 v72, v40, v41
    v_exp_f32 v44, v44
    v_exp_f32 v45, v45
    v_mfma_f32_32x32x16_bf16 v[24:39], v[80:83], v[4:7], v[8:23]
    ds_read_b128 v[80:83], v95 offset:35904
    v_cvt_pk_bf16_f32 v73, v42, v43
    v_exp_f32 v46, v46
    v_exp_f32 v47, v47
    s_add_u32 s39, s38, 57344
    buffer_load_dwordx4 v[236:239], v3, s[4:7], s39 offen offset:0
    v_cvt_pk_bf16_f32 v74, v44, v45
    v_exp_f32 v48, v48
    v_exp_f32 v49, v49
    v_cvt_pk_bf16_f32 v75, v46, v47
    v_exp_f32 v50, v50
    v_exp_f32 v51, v51
    s_waitcnt lgkmcnt(1)
    v_mfma_f32_32x32x16_bf16 v[56:71], v[84:87], v[72:75], v[56:71]
    ds_read_b128 v[88:91], v92 offset:32224
    ds_read_b128 v[84:87], v92 offset:33792
    v_cvt_pk_bf16_f32 v76, v48, v49
    v_exp_f32 v52, v52
    v_exp_f32 v53, v53
    v_cvt_pk_bf16_f32 v77, v50, v51
    v_exp_f32 v54, v54
    v_exp_f32 v55, v55
    v_cvt_pk_bf16_f32 v78, v52, v53
    v_cvt_pk_bf16_f32 v79, v54, v55
    v_exp_f32 v24, v24
    v_exp_f32 v25, v25
    s_waitcnt lgkmcnt(1)
    v_mfma_f32_32x32x16_bf16 v[56:71], v[88:91], v[76:79], v[56:71]
    v_exp_f32 v26, v26
    v_exp_f32 v27, v27
    v_cvt_pk_bf16_f32 v72, v24, v25
    v_exp_f32 v28, v28
    v_exp_f32 v29, v29
    v_mfma_f32_32x32x16_bf16 v[40:55], v[80:83], v[4:7], v[8:23]
    ds_read_b128 v[80:83], v95 offset:38016
    v_cvt_pk_bf16_f32 v73, v26, v27
    v_exp_f32 v30, v30
    v_exp_f32 v31, v31
    s_add_u32 s39, s38, 8192
    buffer_load_dwordx4 v[240:243], v3, s[4:7], s39 offen offset:1024
    v_cvt_pk_bf16_f32 v74, v28, v29
    v_exp_f32 v32, v32
    v_exp_f32 v33, v33
    v_cvt_pk_bf16_f32 v75, v30, v31
    v_exp_f32 v34, v34
    v_exp_f32 v35, v35
    s_waitcnt lgkmcnt(1)
    v_mfma_f32_32x32x16_bf16 v[56:71], v[84:87], v[72:75], v[56:71]
    ds_read_b128 v[88:91], v92 offset:34336
    ds_read_b128 v[84:87], v92 offset:35904
    v_cvt_pk_bf16_f32 v76, v32, v33
    v_exp_f32 v36, v36
    v_exp_f32 v37, v37
    v_cvt_pk_bf16_f32 v77, v34, v35
    v_exp_f32 v38, v38
    v_exp_f32 v39, v39
    v_cvt_pk_bf16_f32 v78, v36, v37
    v_cvt_pk_bf16_f32 v79, v38, v39
    v_exp_f32 v40, v40
    v_exp_f32 v41, v41
    s_waitcnt lgkmcnt(1)
    v_mfma_f32_32x32x16_bf16 v[56:71], v[88:91], v[76:79], v[56:71]
    v_exp_f32 v42, v42
    v_exp_f32 v43, v43
    v_cvt_pk_bf16_f32 v72, v40, v41
    v_exp_f32 v44, v44
    v_exp_f32 v45, v45
    v_mfma_f32_32x32x16_bf16 v[24:39], v[80:83], v[4:7], v[8:23]
    ds_read_b128 v[80:83], v95 offset:40128
    v_cvt_pk_bf16_f32 v73, v42, v43
    v_exp_f32 v46, v46
    v_exp_f32 v47, v47
    s_add_u32 s39, s38, 24576
    buffer_load_dwordx4 v[244:247], v3, s[4:7], s39 offen offset:1024
    v_cvt_pk_bf16_f32 v74, v44, v45
    v_exp_f32 v48, v48
    v_exp_f32 v49, v49
    v_cvt_pk_bf16_f32 v75, v46, v47
    v_exp_f32 v50, v50
    v_exp_f32 v51, v51
    s_waitcnt lgkmcnt(1)
    v_mfma_f32_32x32x16_bf16 v[56:71], v[84:87], v[72:75], v[56:71]
    ds_read_b128 v[88:91], v92 offset:36448
    ds_read_b128 v[84:87], v92 offset:38016
    v_cvt_pk_bf16_f32 v76, v48, v49
    v_exp_f32 v52, v52
    v_exp_f32 v53, v53
    v_cvt_pk_bf16_f32 v77, v50, v51
    v_exp_f32 v54, v54
    v_exp_f32 v55, v55
    v_cvt_pk_bf16_f32 v78, v52, v53
    v_cvt_pk_bf16_f32 v79, v54, v55
    s_waitcnt lgkmcnt(1) vmcnt(21)
    s_barrier
    v_lshlrev_b32 v93, 7, v1
    s_cmp_eq_u32 s3, 0
    s_cselect_b64 exec, 0xffff, 0
    s_mov_b32 s57, 0x18000
    buffer_load_dword v0, v93, s[4:7], s57 offen sc0 sc1
    s_mov_b64 exec, -1
    s_bfe_u32 s56, s2, 0x10002
    s_mul_i32 s56, s56, 7
    s_lshr_b32 s57, s2, 5
    s_add_u32 s56, s56, s57
    s_lshl_b32 s56, s56, 2
    s_bfe_u32 s57, s2, 0x20003
    s_add_u32 s56, s56, s57
    s_lshl_b32 s56, s56, 16
    s_add_u32 s56, s56, 0x950000
    s_setprio 3
    v_exp_f32 v24, v24
    v_exp_f32 v25, v25
    s_waitcnt lgkmcnt(1)
    v_mfma_f32_32x32x16_bf16 v[56:71], v[88:91], v[76:79], v[56:71]
    s_add_u32 m0, s40, 65536
    s_add_u32 s39, s38, 12288
    buffer_load_dwordx4 v3, s[4:7], s39 offen lds
    v_exp_f32 v26, v26
    v_exp_f32 v27, v27
    v_cvt_pk_bf16_f32 v72, v24, v25
    v_exp_f32 v28, v28
    v_exp_f32 v29, v29
    v_mfma_f32_32x32x16_bf16 v[40:55], v[80:83], v[4:7], v[8:23]
    ds_read_b128 v[80:83], v95 offset:42240
    v_cvt_pk_bf16_f32 v73, v26, v27
    v_exp_f32 v30, v30
    v_exp_f32 v31, v31
    s_add_u32 s39, s38, 40960
    buffer_load_dwordx4 v[248:251], v3, s[4:7], s39 offen offset:1024
    v_cvt_pk_bf16_f32 v74, v28, v29
    v_exp_f32 v32, v32
    v_exp_f32 v33, v33
    v_cvt_pk_bf16_f32 v75, v30, v31
    v_exp_f32 v34, v34
    v_exp_f32 v35, v35
    s_waitcnt lgkmcnt(1)
    v_mfma_f32_32x32x16_bf16 v[56:71], v[84:87], v[72:75], v[56:71]
    ds_read_b128 v[88:91], v92 offset:38560
    ds_read_b128 v[84:87], v92 offset:40128
    v_cvt_pk_bf16_f32 v76, v32, v33
    v_exp_f32 v36, v36
    v_exp_f32 v37, v37
    v_cvt_pk_bf16_f32 v77, v34, v35
    v_exp_f32 v38, v38
    v_exp_f32 v39, v39
    v_cvt_pk_bf16_f32 v78, v36, v37
    v_cvt_pk_bf16_f32 v79, v38, v39
    v_exp_f32 v40, v40
    v_exp_f32 v41, v41
    s_waitcnt lgkmcnt(1)
    v_mfma_f32_32x32x16_bf16 v[56:71], v[88:91], v[76:79], v[56:71]
    s_add_u32 m0, s40, 66560
    s_add_u32 s39, s38, 28672
    buffer_load_dwordx4 v3, s[4:7], s39 offen lds
    v_exp_f32 v42, v42
    v_exp_f32 v43, v43
    v_cvt_pk_bf16_f32 v72, v40, v41
    v_exp_f32 v44, v44
    v_exp_f32 v45, v45
    v_mfma_f32_32x32x16_bf16 v[24:39], v[80:83], v[4:7], v[8:23]
    ds_read_b128 v[80:83], v95 offset:44352
    v_cvt_pk_bf16_f32 v73, v42, v43
    v_exp_f32 v46, v46
    v_exp_f32 v47, v47
    s_add_u32 s39, s38, 57344
    buffer_load_dwordx4 v[252:255], v3, s[4:7], s39 offen offset:1024
    v_cvt_pk_bf16_f32 v74, v44, v45
    v_exp_f32 v48, v48
    v_exp_f32 v49, v49
    v_cvt_pk_bf16_f32 v75, v46, v47
    v_exp_f32 v50, v50
    v_exp_f32 v51, v51
    s_waitcnt lgkmcnt(1)
    v_mfma_f32_32x32x16_bf16 v[56:71], v[84:87], v[72:75], v[56:71]
    ds_read_b128 v[88:91], v92 offset:40672
    ds_read_b128 v[84:87], v92 offset:42240
    v_cvt_pk_bf16_f32 v76, v48, v49
    v_exp_f32 v52, v52
    v_exp_f32 v53, v53
    v_cvt_pk_bf16_f32 v77, v50, v51
    v_exp_f32 v54, v54
    v_exp_f32 v55, v55
    v_cvt_pk_bf16_f32 v78, v52, v53
    v_cvt_pk_bf16_f32 v79, v54, v55
    v_exp_f32 v24, v24
    v_exp_f32 v25, v25
    s_waitcnt lgkmcnt(1)
    v_mfma_f32_32x32x16_bf16 v[56:71], v[88:91], v[76:79], v[56:71]
    s_add_u32 m0, s40, 67584
    s_add_u32 s39, s38, 45056
    buffer_load_dwordx4 v3, s[4:7], s39 offen lds
    v_exp_f32 v26, v26
    v_exp_f32 v27, v27
    v_cvt_pk_bf16_f32 v72, v24, v25
    v_exp_f32 v28, v28
    v_exp_f32 v29, v29
    v_mfma_f32_32x32x16_bf16 v[40:55], v[80:83], v[4:7], v[8:23]
    ds_read_b128 v[80:83], v95 offset:46464
    v_cvt_pk_bf16_f32 v73, v26, v27
    v_exp_f32 v30, v30
    v_exp_f32 v31, v31
    v_cvt_pk_bf16_f32 v74, v28, v29
    v_exp_f32 v32, v32
    v_exp_f32 v33, v33
    v_cvt_pk_bf16_f32 v75, v30, v31
    v_exp_f32 v34, v34
    v_exp_f32 v35, v35
    s_waitcnt lgkmcnt(1)
    v_mfma_f32_32x32x16_bf16 v[56:71], v[84:87], v[72:75], v[56:71]
    ds_read_b128 v[88:91], v92 offset:42784
    ds_read_b128 v[84:87], v92 offset:44352
    v_cvt_pk_bf16_f32 v76, v32, v33
    v_exp_f32 v36, v36
    v_exp_f32 v37, v37
    v_cvt_pk_bf16_f32 v77, v34, v35
    v_exp_f32 v38, v38
    v_exp_f32 v39, v39
    v_cvt_pk_bf16_f32 v78, v36, v37
    v_cvt_pk_bf16_f32 v79, v38, v39
    v_exp_f32 v40, v40
    v_exp_f32 v41, v41
    s_waitcnt lgkmcnt(1)
    v_mfma_f32_32x32x16_bf16 v[56:71], v[88:91], v[76:79], v[56:71]
    s_add_u32 m0, s40, 68608
    s_add_u32 s39, s38, 61440
    buffer_load_dwordx4 v3, s[4:7], s39 offen lds
    v_exp_f32 v42, v42
    v_exp_f32 v43, v43
    v_cvt_pk_bf16_f32 v72, v40, v41
    v_exp_f32 v44, v44
    v_exp_f32 v45, v45
    v_mfma_f32_32x32x16_bf16 v[24:39], v[80:83], v[4:7], v[8:23]
    ds_read_b128 v[80:83], v95 offset:48576
    v_cvt_pk_bf16_f32 v73, v42, v43
    v_exp_f32 v46, v46
    v_exp_f32 v47, v47
    v_cvt_pk_bf16_f32 v74, v44, v45
    v_exp_f32 v48, v48
    v_exp_f32 v49, v49
    v_cvt_pk_bf16_f32 v75, v46, v47
    v_exp_f32 v50, v50
    v_exp_f32 v51, v51
    s_waitcnt lgkmcnt(1)
    v_mfma_f32_32x32x16_bf16 v[56:71], v[84:87], v[72:75], v[56:71]
    ds_read_b128 v[88:91], v92 offset:44896
    ds_read_b128 v[84:87], v92 offset:46464
    v_cvt_pk_bf16_f32 v76, v48, v49
    v_exp_f32 v52, v52
    v_exp_f32 v53, v53
    v_cvt_pk_bf16_f32 v77, v50, v51
    v_exp_f32 v54, v54
    v_exp_f32 v55, v55
    v_cvt_pk_bf16_f32 v78, v52, v53
    v_cvt_pk_bf16_f32 v79, v54, v55
    s_setprio 2
    v_exp_f32 v24, v24
    v_exp_f32 v25, v25
    s_waitcnt lgkmcnt(1)
    v_mfma_f32_32x32x16_bf16 v[56:71], v[88:91], v[76:79], v[56:71]
    v_exp_f32 v26, v26
    v_exp_f32 v27, v27
    v_cvt_pk_bf16_f32 v72, v24, v25
    v_exp_f32 v28, v28
    v_exp_f32 v29, v29
    v_mfma_f32_32x32x16_bf16 v[40:55], v[80:83], v[4:7], v[8:23]
    ds_read_b128 v[80:83], v95 offset:50688
    v_cvt_pk_bf16_f32 v73, v26, v27
    v_exp_f32 v30, v30
    v_exp_f32 v31, v31
    v_cvt_pk_bf16_f32 v74, v28, v29
    v_exp_f32 v32, v32
    v_exp_f32 v33, v33
    v_cvt_pk_bf16_f32 v75, v30, v31
    v_exp_f32 v34, v34
    v_exp_f32 v35, v35
    s_waitcnt lgkmcnt(1)
    v_mfma_f32_32x32x16_bf16 v[56:71], v[84:87], v[72:75], v[56:71]
    ds_read_b128 v[88:91], v92 offset:47008
    ds_read_b128 v[84:87], v92 offset:48576
    v_cvt_pk_bf16_f32 v76, v32, v33
    v_exp_f32 v36, v36
    v_exp_f32 v37, v37
    v_cvt_pk_bf16_f32 v77, v34, v35
    v_exp_f32 v38, v38
    v_exp_f32 v39, v39
    v_cvt_pk_bf16_f32 v78, v36, v37
    v_cvt_pk_bf16_f32 v79, v38, v39
    v_exp_f32 v40, v40
    v_exp_f32 v41, v41
    s_waitcnt lgkmcnt(1)
    v_mfma_f32_32x32x16_bf16 v[56:71], v[88:91], v[76:79], v[56:71]
    v_exp_f32 v42, v42
    v_exp_f32 v43, v43
    v_cvt_pk_bf16_f32 v72, v40, v41
    v_exp_f32 v44, v44
    v_exp_f32 v45, v45
    v_mfma_f32_32x32x16_bf16 v[24:39], v[80:83], v[4:7], v[8:23]
    ds_read_b128 v[80:83], v95 offset:52800
    v_cvt_pk_bf16_f32 v73, v42, v43
    v_exp_f32 v46, v46
    v_exp_f32 v47, v47
    v_cvt_pk_bf16_f32 v74, v44, v45
    v_exp_f32 v48, v48
    v_exp_f32 v49, v49
    v_cvt_pk_bf16_f32 v75, v46, v47
    v_exp_f32 v50, v50
    v_exp_f32 v51, v51
    s_waitcnt lgkmcnt(1)
    v_mfma_f32_32x32x16_bf16 v[56:71], v[84:87], v[72:75], v[56:71]
    ds_read_b128 v[88:91], v92 offset:49120
    ds_read_b128 v[84:87], v92 offset:50688
    v_cvt_pk_bf16_f32 v76, v48, v49
    v_exp_f32 v52, v52
    v_exp_f32 v53, v53
    v_cvt_pk_bf16_f32 v77, v50, v51
    v_exp_f32 v54, v54
    v_exp_f32 v55, v55
    v_cvt_pk_bf16_f32 v78, v52, v53
    v_cvt_pk_bf16_f32 v79, v54, v55
    v_exp_f32 v24, v24
    v_exp_f32 v25, v25
    s_waitcnt lgkmcnt(1)
    v_mfma_f32_32x32x16_bf16 v[56:71], v[88:91], v[76:79], v[56:71]
    v_exp_f32 v26, v26
    v_exp_f32 v27, v27
    v_cvt_pk_bf16_f32 v72, v24, v25
    v_exp_f32 v28, v28
    v_exp_f32 v29, v29
    v_mfma_f32_32x32x16_bf16 v[40:55], v[80:83], v[4:7], v[8:23]
    ds_read_b128 v[80:83], v95 offset:54912
    v_cvt_pk_bf16_f32 v73, v26, v27
    v_exp_f32 v30, v30
    v_exp_f32 v31, v31
    v_cvt_pk_bf16_f32 v74, v28, v29
    v_exp_f32 v32, v32
    v_exp_f32 v33, v33
    v_cvt_pk_bf16_f32 v75, v30, v31
    v_exp_f32 v34, v34
    v_exp_f32 v35, v35
    s_waitcnt lgkmcnt(1)
    v_mfma_f32_32x32x16_bf16 v[56:71], v[84:87], v[72:75], v[56:71]
    ds_read_b128 v[88:91], v92 offset:51232
    ds_read_b128 v[84:87], v92 offset:52800
    v_cvt_pk_bf16_f32 v76, v32, v33
    v_exp_f32 v36, v36
    v_exp_f32 v37, v37
    v_cvt_pk_bf16_f32 v77, v34, v35
    v_exp_f32 v38, v38
    v_exp_f32 v39, v39
    v_cvt_pk_bf16_f32 v78, v36, v37
    v_cvt_pk_bf16_f32 v79, v38, v39
    s_waitcnt vmcnt(6)
    v_cmp_eq_u32 vcc, 16, v0
    s_and_b32 s42, vcc_lo, 0xffff
    s_cmp_eq_u32 s42, 0xffff
    s_cselect_b32 s42, s3, 1
    s_cmp_eq_u32 s42, 0
    s_cselect_b64 s[42:43], -1, 0
    s_mov_b64 exec, s[42:43]
    buffer_load_dword v0, v93, s[4:7], s56 offen
    s_mov_b64 exec, -1
    s_add_u32 s56, s56, 8192
    v_exp_f32 v40, v40
    v_exp_f32 v41, v41
    s_waitcnt lgkmcnt(1)
    v_mfma_f32_32x32x16_bf16 v[56:71], v[88:91], v[76:79], v[56:71]
    v_exp_f32 v42, v42
    v_exp_f32 v43, v43
    v_cvt_pk_bf16_f32 v72, v40, v41
    v_exp_f32 v44, v44
    v_exp_f32 v45, v45
    v_mfma_f32_32x32x16_bf16 v[24:39], v[80:83], v[4:7], v[8:23]
    ds_read_b128 v[80:83], v95 offset:57024
    v_cvt_pk_bf16_f32 v73, v42, v43
    v_exp_f32 v46, v46
    v_exp_f32 v47, v47
    v_cvt_pk_bf16_f32 v74, v44, v45
    v_exp_f32 v48, v48
    v_exp_f32 v49, v49
    v_cvt_pk_bf16_f32 v75, v46, v47
    v_exp_f32 v50, v50
    v_exp_f32 v51, v51
    s_waitcnt lgkmcnt(1)
    v_mfma_f32_32x32x16_bf16 v[56:71], v[84:87], v[72:75], v[56:71]
    ds_read_b128 v[88:91], v92 offset:53344
    ds_read_b128 v[84:87], v92 offset:54912
    v_cvt_pk_bf16_f32 v76, v48, v49
    v_exp_f32 v52, v52
    v_exp_f32 v53, v53
    v_cvt_pk_bf16_f32 v77, v50, v51
    v_exp_f32 v54, v54
    v_exp_f32 v55, v55
    v_cvt_pk_bf16_f32 v78, v52, v53
    v_cvt_pk_bf16_f32 v79, v54, v55
    s_mov_b64 exec, s[42:43]
    buffer_load_dword v0, v93, s[4:7], s56 offen
    s_mov_b64 exec, -1
    s_add_u32 s56, s56, 8192
    s_setprio 1
    v_exp_f32 v24, v24
    v_exp_f32 v25, v25
    s_waitcnt lgkmcnt(1)
    v_mfma_f32_32x32x16_bf16 v[56:71], v[88:91], v[76:79], v[56:71]
    v_exp_f32 v26, v26
    v_exp_f32 v27, v27
    v_cvt_pk_bf16_f32 v72, v24, v25
    v_exp_f32 v28, v28
    v_exp_f32 v29, v29
    v_mfma_f32_32x32x16_bf16 v[40:55], v[80:83], v[4:7], v[8:23]
    ds_read_b128 v[80:83], v95 offset:59136
    v_cvt_pk_bf16_f32 v73, v26, v27
    v_exp_f32 v30, v30
    v_exp_f32 v31, v31
    v_cvt_pk_bf16_f32 v74, v28, v29
    v_exp_f32 v32, v32
    v_exp_f32 v33, v33
    v_cvt_pk_bf16_f32 v75, v30, v31
    v_exp_f32 v34, v34
    v_exp_f32 v35, v35
    s_waitcnt lgkmcnt(1)
    v_mfma_f32_32x32x16_bf16 v[56:71], v[84:87], v[72:75], v[56:71]
    ds_read_b128 v[88:91], v92 offset:55456
    ds_read_b128 v[84:87], v92 offset:57024
    v_cvt_pk_bf16_f32 v76, v32, v33
    v_exp_f32 v36, v36
    v_exp_f32 v37, v37
    v_cvt_pk_bf16_f32 v77, v34, v35
    v_exp_f32 v38, v38
    v_exp_f32 v39, v39
    v_cvt_pk_bf16_f32 v78, v36, v37
    v_cvt_pk_bf16_f32 v79, v38, v39
    s_mov_b64 exec, s[42:43]
    buffer_load_dword v0, v93, s[4:7], s56 offen
    s_mov_b64 exec, -1
    s_add_u32 s56, s56, 8192
    v_exp_f32 v40, v40
    v_exp_f32 v41, v41
    s_waitcnt lgkmcnt(1)
    v_mfma_f32_32x32x16_bf16 v[56:71], v[88:91], v[76:79], v[56:71]
    v_exp_f32 v42, v42
    v_exp_f32 v43, v43
    v_cvt_pk_bf16_f32 v72, v40, v41
    v_exp_f32 v44, v44
    v_exp_f32 v45, v45
    v_mfma_f32_32x32x16_bf16 v[24:39], v[80:83], v[4:7], v[8:23]
    ds_read_b128 v[80:83], v95 offset:61248
    v_cvt_pk_bf16_f32 v73, v42, v43
    v_exp_f32 v46, v46
    v_exp_f32 v47, v47
    v_cvt_pk_bf16_f32 v74, v44, v45
    v_exp_f32 v48, v48
    v_exp_f32 v49, v49
    v_cvt_pk_bf16_f32 v75, v46, v47
    v_exp_f32 v50, v50
    v_exp_f32 v51, v51
    s_waitcnt lgkmcnt(1)
    v_mfma_f32_32x32x16_bf16 v[56:71], v[84:87], v[72:75], v[56:71]
    ds_read_b128 v[88:91], v92 offset:57568
    ds_read_b128 v[84:87], v92 offset:59136
    v_cvt_pk_bf16_f32 v76, v48, v49
    v_exp_f32 v52, v52
    v_exp_f32 v53, v53
    v_cvt_pk_bf16_f32 v77, v50, v51
    v_exp_f32 v54, v54
    v_exp_f32 v55, v55
    v_cvt_pk_bf16_f32 v78, v52, v53
    v_cvt_pk_bf16_f32 v79, v54, v55
    s_mov_b64 exec, s[42:43]
    buffer_load_dword v0, v93, s[4:7], s56 offen
    s_mov_b64 exec, -1
    s_add_u32 s56, s56, 8192
    v_exp_f32 v24, v24
    v_exp_f32 v25, v25
    s_waitcnt lgkmcnt(1)
    v_mfma_f32_32x32x16_bf16 v[56:71], v[88:91], v[76:79], v[56:71]
    v_exp_f32 v26, v26
    v_exp_f32 v27, v27
    v_cvt_pk_bf16_f32 v72, v24, v25
    v_exp_f32 v28, v28
    v_exp_f32 v29, v29
    v_mfma_f32_32x32x16_bf16 v[40:55], v[80:83], v[4:7], v[8:23]
    ds_read_b128 v[80:83], v95 offset:63360
    v_cvt_pk_bf16_f32 v73, v26, v27
    v_exp_f32 v30, v30
    v_exp_f32 v31, v31
    v_cvt_pk_bf16_f32 v74, v28, v29
    v_exp_f32 v32, v32
    v_exp_f32 v33, v33
    v_cvt_pk_bf16_f32 v75, v30, v31
    v_exp_f32 v34, v34
    v_exp_f32 v35, v35
    s_waitcnt lgkmcnt(1)
    v_mfma_f32_32x32x16_bf16 v[56:71], v[84:87], v[72:75], v[56:71]
    ds_read_b128 v[88:91], v92 offset:59680
    ds_read_b128 v[84:87], v92 offset:61248
    v_cvt_pk_bf16_f32 v76, v32, v33
    v_exp_f32 v36, v36
    v_exp_f32 v37, v37
    v_cvt_pk_bf16_f32 v77, v34, v35
    v_exp_f32 v38, v38
    v_exp_f32 v39, v39
    v_cvt_pk_bf16_f32 v78, v36, v37
    v_cvt_pk_bf16_f32 v79, v38, v39
    s_mov_b64 exec, s[42:43]
    buffer_load_dword v0, v93, s[4:7], s56 offen
    s_mov_b64 exec, -1
    s_add_u32 s56, s56, 8192
    v_exp_f32 v40, v40
    v_exp_f32 v41, v41
    s_waitcnt lgkmcnt(1)
    v_mfma_f32_32x32x16_bf16 v[56:71], v[88:91], v[76:79], v[56:71]
    v_exp_f32 v42, v42
    v_exp_f32 v43, v43
    v_cvt_pk_bf16_f32 v72, v40, v41
    v_exp_f32 v44, v44
    v_exp_f32 v45, v45
    v_mfma_f32_32x32x16_bf16 v[24:39], v[80:83], v[4:7], v[8:23]
    v_add_u32 v95, 63360, v95
    ds_read_b128 v[80:83], v95 offset:2112
    v_cvt_pk_bf16_f32 v73, v42, v43
    v_exp_f32 v46, v46
    v_exp_f32 v47, v47
    v_cvt_pk_bf16_f32 v74, v44, v45
    v_exp_f32 v48, v48
    v_exp_f32 v49, v49
    v_cvt_pk_bf16_f32 v75, v46, v47
    v_exp_f32 v50, v50
    v_exp_f32 v51, v51
    s_waitcnt lgkmcnt(1)
    v_mfma_f32_32x32x16_bf16 v[56:71], v[84:87], v[72:75], v[56:71]
    ds_read_b128 v[88:91], v92 offset:61792
    ds_read_b128 v[84:87], v92 offset:63360
    v_cvt_pk_bf16_f32 v76, v48, v49
    v_exp_f32 v52, v52
    v_exp_f32 v53, v53
    v_cvt_pk_bf16_f32 v77, v50, v51
    v_exp_f32 v54, v54
    v_exp_f32 v55, v55
    v_cvt_pk_bf16_f32 v78, v52, v53
    v_cvt_pk_bf16_f32 v79, v54, v55
    s_mov_b64 exec, s[42:43]
    buffer_load_dword v0, v93, s[4:7], s56 offen
    s_mov_b64 exec, -1
    s_add_u32 s56, s56, 8192
    s_setprio 0
    v_exp_f32 v24, v24
    v_exp_f32 v25, v25
    s_waitcnt lgkmcnt(1)
    v_mfma_f32_32x32x16_bf16 v[56:71], v[88:91], v[76:79], v[56:71]
    v_exp_f32 v26, v26
    v_exp_f32 v27, v27
    v_cvt_pk_bf16_f32 v72, v24, v25
    v_exp_f32 v28, v28
    v_exp_f32 v29, v29
    v_mfma_f32_32x32x16_bf16 v[40:55], v[80:83], v[4:7], v[8:23]
    ds_read_b128 v[80:83], v95 offset:4224
    v_cvt_pk_bf16_f32 v73, v26, v27
    v_exp_f32 v30, v30
    v_exp_f32 v31, v31
    v_cvt_pk_bf16_f32 v74, v28, v29
    v_exp_f32 v32, v32
    v_exp_f32 v33, v33
    v_cvt_pk_bf16_f32 v75, v30, v31
    v_exp_f32 v34, v34
    v_exp_f32 v35, v35
    s_waitcnt lgkmcnt(1)
    v_mfma_f32_32x32x16_bf16 v[56:71], v[84:87], v[72:75], v[56:71]
    ds_read_b128 v[88:91], v92 offset:63904
    v_add_u32 v92, 63360, v92
    ds_read_b128 v[84:87], v92 offset:2112
    v_cvt_pk_bf16_f32 v76, v32, v33
    v_exp_f32 v36, v36
    v_exp_f32 v37, v37
    v_cvt_pk_bf16_f32 v77, v34, v35
    v_exp_f32 v38, v38
    v_exp_f32 v39, v39
    v_cvt_pk_bf16_f32 v78, v36, v37
    v_cvt_pk_bf16_f32 v79, v38, v39
    s_mov_b64 exec, s[42:43]
    buffer_load_dword v0, v93, s[4:7], s56 offen
    s_mov_b64 exec, -1
    s_add_u32 s56, s56, 8192
    v_exp_f32 v40, v40
    v_exp_f32 v41, v41
    s_waitcnt lgkmcnt(1)
    v_mfma_f32_32x32x16_bf16 v[56:71], v[88:91], v[76:79], v[56:71]
    v_exp_f32 v42, v42
    v_exp_f32 v43, v43
    v_cvt_pk_bf16_f32 v72, v40, v41
    v_exp_f32 v44, v44
    v_exp_f32 v45, v45
    v_mfma_f32_32x32x16_bf16 v[24:39], v[80:83], v[4:7], v[8:23]
    ds_read_b128 v[80:83], v95 offset:6336
    v_cvt_pk_bf16_f32 v73, v42, v43
    v_exp_f32 v46, v46
    v_exp_f32 v47, v47
    v_cvt_pk_bf16_f32 v74, v44, v45
    v_exp_f32 v48, v48
    v_exp_f32 v49, v49
    v_cvt_pk_bf16_f32 v75, v46, v47
    v_exp_f32 v50, v50
    v_exp_f32 v51, v51
    s_waitcnt lgkmcnt(1)
    v_mfma_f32_32x32x16_bf16 v[56:71], v[84:87], v[72:75], v[56:71]
    ds_read_b128 v[88:91], v92 offset:2656
    ds_read_b128 v[84:87], v92 offset:4224
    v_cvt_pk_bf16_f32 v76, v48, v49
    v_exp_f32 v52, v52
    v_exp_f32 v53, v53
    v_cvt_pk_bf16_f32 v77, v50, v51
    v_exp_f32 v54, v54
    v_exp_f32 v55, v55
    v_cvt_pk_bf16_f32 v78, v52, v53
    v_cvt_pk_bf16_f32 v79, v54, v55
    s_mov_b64 exec, s[42:43]
    buffer_load_dword v0, v93, s[4:7], s56 offen
    s_mov_b64 exec, -1
    s_add_u32 s56, s56, 8192
    v_exp_f32 v24, v24
    v_exp_f32 v25, v25
    s_waitcnt lgkmcnt(1)
    v_mfma_f32_32x32x16_bf16 v[56:71], v[88:91], v[76:79], v[56:71]
    v_exp_f32 v26, v26
    v_exp_f32 v27, v27
    v_cvt_pk_bf16_f32 v72, v24, v25
    v_exp_f32 v28, v28
    v_exp_f32 v29, v29
    v_mfma_f32_32x32x16_bf16 v[40:55], v[80:83], v[4:7], v[8:23]
    v_cvt_pk_bf16_f32 v73, v26, v27
    v_exp_f32 v30, v30
    v_exp_f32 v31, v31
    v_cvt_pk_bf16_f32 v74, v28, v29
    v_exp_f32 v32, v32
    v_exp_f32 v33, v33
    v_cvt_pk_bf16_f32 v75, v30, v31
    v_exp_f32 v34, v34
    v_exp_f32 v35, v35
    s_waitcnt lgkmcnt(0)
    v_mfma_f32_32x32x16_bf16 v[56:71], v[84:87], v[72:75], v[56:71]
    ds_read_b128 v[88:91], v92 offset:4768
    ds_read_b128 v[84:87], v92 offset:6336
    v_cvt_pk_bf16_f32 v76, v32, v33
    v_exp_f32 v36, v36
    v_exp_f32 v37, v37
    v_cvt_pk_bf16_f32 v77, v34, v35
    v_exp_f32 v38, v38
    v_exp_f32 v39, v39
    v_cvt_pk_bf16_f32 v78, v36, v37
    v_cvt_pk_bf16_f32 v79, v38, v39
    v_exp_f32 v40, v40
    v_exp_f32 v41, v41
    s_waitcnt lgkmcnt(1)
    v_mfma_f32_32x32x16_bf16 v[56:71], v[88:91], v[76:79], v[56:71]
    v_exp_f32 v42, v42
    v_exp_f32 v43, v43
    v_cvt_pk_bf16_f32 v72, v40, v41
    v_exp_f32 v44, v44
    v_exp_f32 v45, v45
    v_cvt_pk_bf16_f32 v73, v42, v43
    v_exp_f32 v46, v46
    v_exp_f32 v47, v47
    v_cvt_pk_bf16_f32 v74, v44, v45
    v_exp_f32 v48, v48
    v_exp_f32 v49, v49
    v_cvt_pk_bf16_f32 v75, v46, v47
    v_exp_f32 v50, v50
    v_exp_f32 v51, v51
    s_waitcnt lgkmcnt(0)
    v_mfma_f32_32x32x16_bf16 v[56:71], v[84:87], v[72:75], v[56:71]
    ds_read_b128 v[88:91], v92 offset:6880
    ds_read_b128 v[84:87], v92 offset:6336
    v_cvt_pk_bf16_f32 v76, v48, v49
    v_exp_f32 v52, v52
    v_exp_f32 v53, v53
    v_cvt_pk_bf16_f32 v77, v50, v51
    v_exp_f32 v54, v54
    v_exp_f32 v55, v55
    v_cvt_pk_bf16_f32 v78, v52, v53
    v_cvt_pk_bf16_f32 v79, v54, v55
    s_waitcnt lgkmcnt(0)
    s_nop 0
    v_mfma_f32_32x32x16_bf16 v[56:71], v[88:91], v[76:79], v[56:71]
    s_nop 11
    v_max3_f32 v72, |v56|, |v57|, |v58|
    v_max3_f32 v72, |v59|, |v60|, v72
    v_max3_f32 v72, |v61|, |v62|, v72
    v_max_f32 v72, |v63|, v72
    v_add_f32 v73, v56, v57
    v_add_f32 v74, v58, v59
    v_add_f32 v75, v60, v61
    v_add_f32 v76, v62, v63
    v_add_f32 v73, v73, v74
    v_add_f32 v75, v75, v76
    v_add_f32 v73, v73, v75
    v_add_f32 v73, v73, v64
    v_mov_b32 v74, 0x207
    v_cmp_class_f32 s[36:37], v73, v74
    v_cmp_gt_f32 vcc, 0x0f800000, v72
    s_nop 1
    s_or_b64 s[36:37], s[36:37], vcc
    s_cmp_lg_u64 s[36:37], 0
    s_cbranch_scc1 k2_slow
k2_tail:
    v_mov_b32 v76, v64
    s_nop 1
    v_permlane32_swap_b32 v64, v76
    s_nop 1
    v_rcp_f32 v76, v64
    v_lshlrev_b32 v2, 7, v1
    v_mul_f32 v56, v56, v76
    v_mul_f32 v57, v57, v76
    v_mul_f32 v58, v58, v76
    v_mul_f32 v59, v59, v76
    v_mul_f32 v60, v60, v76
    v_mul_f32 v61, v61, v76
    v_mul_f32 v62, v62, v76
    v_mul_f32 v63, v63, v76
    v_cvt_pk_bf16_f32 v72, v56, v57
    v_cvt_pk_bf16_f32 v73, v58, v59
    v_cvt_pk_bf16_f32 v74, v60, v61
    v_cvt_pk_bf16_f32 v75, v62, v63
    s_lshl_b32 s37, s3, 4
    s_add_u32 s37, s37, 155648
    v_add_u32 v2, s37, v2
    ds_write_b128 v2, v[72:75]
    v_lshlrev_b32 v94, 5, v1
    v_lshrrev_b32 v2, 4, v1
    v_lshlrev_b32 v2, 7, v2
    v_and_b32 v93, 7, v1
    v_lshl_add_u32 v2, v93, 4, v2
    v_add_u32 v2, 155648, v2
    v_add_u32 v92, s40, v3
    v_add_u32 v95, 0x10000, v92
    s_add_u32 s39, s38, 12288
    buffer_load_dwordx4 v[8:11], v3, s[4:7], s39 offen offset:1024
    s_add_u32 s39, s38, 28672
    buffer_load_dwordx4 v[12:15], v3, s[4:7], s39 offen offset:1024
    s_waitcnt lgkmcnt(0)
    s_barrier
    ds_read_b128 v[72:75], v2 offset:0
    ds_read_b128 v[76:79], v2 offset:512
    ds_read_b128 v[80:83], v2 offset:1024
    ds_read_b128 v[84:87], v2 offset:1536
    ds_read_b128 v[88:91], v2 offset:2048
    s_waitcnt lgkmcnt(4) vmcnt(10)
    v_mfma_f32_16x16x32_bf16 v[56:59], v[96:99], v[72:75], 0
    v_mfma_f32_16x16x32_bf16 v[60:63], v[100:103], v[72:75], 0
    v_mfma_f32_16x16x32_bf16 v[64:67], v[104:107], v[72:75], 0
    v_mfma_f32_16x16x32_bf16 v[68:71], v[108:111], v[72:75], 0
    s_add_u32 s39, s38, 45056
    buffer_load_dwordx4 v[16:19], v3, s[4:7], s39 offen offset:1024
    s_add_u32 s39, s38, 61440
    buffer_load_dwordx4 v[20:23], v3, s[4:7], s39 offen offset:1024
    ds_read_b128 v[72:75], v2 offset:2560
    s_waitcnt lgkmcnt(4)
    v_mfma_f32_16x16x32_bf16 v[56:59], v[112:115], v[76:79], v[56:59]
    v_mfma_f32_16x16x32_bf16 v[60:63], v[116:119], v[76:79], v[60:63]
    v_mfma_f32_16x16x32_bf16 v[64:67], v[120:123], v[76:79], v[64:67]
    v_mfma_f32_16x16x32_bf16 v[68:71], v[124:127], v[76:79], v[68:71]
    s_add_u32 s39, s38, 12288
    buffer_load_dwordx4 v[24:27], v3, s[4:7], s39 offen offset:2048
    s_add_u32 s39, s38, 28672
    buffer_load_dwordx4 v[28:31], v3, s[4:7], s39 offen offset:2048
    ds_read_b128 v[76:79], v2 offset:3072
    s_waitcnt lgkmcnt(4)
    v_mfma_f32_16x16x32_bf16 v[56:59], v[128:131], v[80:83], v[56:59]
    v_mfma_f32_16x16x32_bf16 v[60:63], v[132:135], v[80:83], v[60:63]
    v_mfma_f32_16x16x32_bf16 v[64:67], v[136:139], v[80:83], v[64:67]
    v_mfma_f32_16x16x32_bf16 v[68:71], v[140:143], v[80:83], v[68:71]
    s_add_u32 s39, s38, 45056
    buffer_load_dwordx4 v[32:35], v3, s[4:7], s39 offen offset:2048
    s_add_u32 s39, s38, 61440
    buffer_load_dwordx4 v[36:39], v3, s[4:7], s39 offen offset:2048
    ds_read_b128 v[80:83], v2 offset:3584
    ds_read_b128 v[96:99], v92 offset:0
    ds_read_b128 v[100:103], v92 offset:1024
    s_waitcnt lgkmcnt(6)
    v_mfma_f32_16x16x32_bf16 v[56:59], v[144:147], v[84:87], v[56:59]
    v_mfma_f32_16x16x32_bf16 v[60:63], v[148:151], v[84:87], v[60:63]
    v_mfma_f32_16x16x32_bf16 v[64:67], v[152:155], v[84:87], v[64:67]
    v_mfma_f32_16x16x32_bf16 v[68:71], v[156:159], v[84:87], v[68:71]
    s_add_u32 s39, s38, 12288
    buffer_load_dwordx4 v[40:43], v3, s[4:7], s39 offen offset:3072
    s_add_u32 s39, s38, 28672
    buffer_load_dwordx4 v[44:47], v3, s[4:7], s39 offen offset:3072
    ds_read_b128 v[84:87], v2 offset:4096
    ds_read_b128 v[104:107], v92 offset:2048
    ds_read_b128 v[108:111], v92 offset:3072
    s_waitcnt lgkmcnt(8)
    v_mfma_f32_16x16x32_bf16 v[56:59], v[160:163], v[88:91], v[56:59]
    v_mfma_f32_16x16x32_bf16 v[60:63], v[164:167], v[88:91], v[60:63]
    v_mfma_f32_16x16x32_bf16 v[64:67], v[168:171], v[88:91], v[64:67]
    v_mfma_f32_16x16x32_bf16 v[68:71], v[172:175], v[88:91], v[68:71]
    s_add_u32 s39, s38, 45056
    buffer_load_dwordx4 v[48:51], v3, s[4:7], s39 offen offset:3072
    s_add_u32 s39, s38, 61440
    buffer_load_dwordx4 v[52:55], v3, s[4:7], s39 offen offset:3072
    ds_read_b128 v[88:91], v2 offset:4608
    ds_read_b128 v[112:115], v92 offset:32768
    ds_read_b128 v[116:119], v92 offset:33792
    s_waitcnt lgkmcnt(10)
    v_mfma_f32_16x16x32_bf16 v[56:59], v[176:179], v[72:75], v[56:59]
    v_mfma_f32_16x16x32_bf16 v[60:63], v[180:183], v[72:75], v[60:63]
    v_mfma_f32_16x16x32_bf16 v[64:67], v[184:187], v[72:75], v[64:67]
    v_mfma_f32_16x16x32_bf16 v[68:71], v[188:191], v[72:75], v[68:71]
    ds_read_b128 v[72:75], v2 offset:5120
    ds_read_b128 v[120:123], v92 offset:34816
    ds_read_b128 v[124:127], v92 offset:35840
    s_waitcnt lgkmcnt(12)
    v_mfma_f32_16x16x32_bf16 v[56:59], v[192:195], v[76:79], v[56:59]
    v_mfma_f32_16x16x32_bf16 v[60:63], v[196:199], v[76:79], v[60:63]
    v_mfma_f32_16x16x32_bf16 v[64:67], v[200:203], v[76:79], v[64:67]
    v_mfma_f32_16x16x32_bf16 v[68:71], v[204:207], v[76:79], v[68:71]
    ds_read_b128 v[76:79], v2 offset:5632
    ds_read_b128 v[128:131], v95 offset:0
    ds_read_b128 v[132:135], v95 offset:1024
    s_waitcnt lgkmcnt(14)
    v_mfma_f32_16x16x32_bf16 v[56:59], v[208:211], v[80:83], v[56:59]
    v_mfma_f32_16x16x32_bf16 v[60:63], v[212:215], v[80:83], v[60:63]
    v_mfma_f32_16x16x32_bf16 v[64:67], v[216:219], v[80:83], v[64:67]
    v_mfma_f32_16x16x32_bf16 v[68:71], v[220:223], v[80:83], v[68:71]
    ds_read_b128 v[80:83], v2 offset:6144
    ds_read_b128 v[136:139], v95 offset:2048
    ds_read_b128 v[140:143], v95 offset:3072
    s_waitcnt lgkmcnt(14)
    v_mfma_f32_16x16x32_bf16 v[56:59], v[224:227], v[84:87], v[56:59]
    v_mfma_f32_16x16x32_bf16 v[60:63], v[228:231], v[84:87], v[60:63]
    v_mfma_f32_16x16x32_bf16 v[64:67], v[232:235], v[84:87], v[64:67]
    v_mfma_f32_16x16x32_bf16 v[68:71], v[236:239], v[84:87], v[68:71]
    ds_read_b128 v[84:87], v2 offset:6656
    s_waitcnt lgkmcnt(12)
    v_mfma_f32_16x16x32_bf16 v[56:59], v[240:243], v[88:91], v[56:59]
    v_mfma_f32_16x16x32_bf16 v[60:63], v[244:247], v[88:91], v[60:63]
    v_mfma_f32_16x16x32_bf16 v[64:67], v[248:251], v[88:91], v[64:67]
    v_mfma_f32_16x16x32_bf16 v[68:71], v[252:255], v[88:91], v[68:71]
    ds_read_b128 v[88:91], v2 offset:7168
    s_waitcnt lgkmcnt(10)
    v_mfma_f32_16x16x32_bf16 v[56:59], v[96:99], v[72:75], v[56:59]
    v_mfma_f32_16x16x32_bf16 v[60:63], v[100:103], v[72:75], v[60:63]
    v_mfma_f32_16x16x32_bf16 v[64:67], v[104:107], v[72:75], v[64:67]
    v_mfma_f32_16x16x32_bf16 v[68:71], v[108:111], v[72:75], v[68:71]
    ds_read_b128 v[72:75], v2 offset:7680
    s_waitcnt lgkmcnt(8)
    v_mfma_f32_16x16x32_bf16 v[56:59], v[112:115], v[76:79], v[56:59]
    v_mfma_f32_16x16x32_bf16 v[60:63], v[116:119], v[76:79], v[60:63]
    v_mfma_f32_16x16x32_bf16 v[64:67], v[120:123], v[76:79], v[64:67]
    v_mfma_f32_16x16x32_bf16 v[68:71], v[124:127], v[76:79], v[68:71]
    v_lshlrev_b32 v250, 7, v1
    s_cmp_eq_u32 s3, 0
    s_cselect_b64 exec, 0xffff, 0
    s_mov_b32 s57, 0x18000
    buffer_load_dword v251, v250, s[4:7], s57 offen sc0 sc1
    s_mov_b64 exec, -1
    s_waitcnt lgkmcnt(3)
    v_mfma_f32_16x16x32_bf16 v[56:59], v[128:131], v[80:83], v[56:59]
    v_mfma_f32_16x16x32_bf16 v[60:63], v[132:135], v[80:83], v[60:63]
    v_mfma_f32_16x16x32_bf16 v[64:67], v[136:139], v[80:83], v[64:67]
    v_mfma_f32_16x16x32_bf16 v[68:71], v[140:143], v[80:83], v[68:71]
    v_add_u32 v93, 149504, v94
    s_add_u32 s37, s27, 141312
    v_add_u32 v92, s37, v3
    ds_read_b128 v[4:7], v92 offset:0
    ds_read_b128 v[160:163], v93 offset:0
    ds_read_b128 v[164:167], v93 offset:16
    ds_read_b128 v[168:171], v93 offset:2048
    ds_read_b128 v[172:175], v93 offset:2064
    ds_read_b128 v[176:179], v93 offset:4096
    ds_read_b128 v[180:183], v93 offset:4112
    s_waitcnt lgkmcnt(9) vmcnt(9)
    v_mfma_f32_16x16x32_bf16 v[56:59], v[8:11], v[84:87], v[56:59]
    v_mfma_f32_16x16x32_bf16 v[60:63], v[12:15], v[84:87], v[60:63]
    v_mfma_f32_16x16x32_bf16 v[64:67], v[16:19], v[84:87], v[64:67]
    v_mfma_f32_16x16x32_bf16 v[68:71], v[20:23], v[84:87], v[68:71]
    s_waitcnt lgkmcnt(8) vmcnt(5)
    v_mfma_f32_16x16x32_bf16 v[56:59], v[24:27], v[88:91], v[56:59]
    v_mfma_f32_16x16x32_bf16 v[60:63], v[28:31], v[88:91], v[60:63]
    v_mfma_f32_16x16x32_bf16 v[64:67], v[32:35], v[88:91], v[64:67]
    v_mfma_f32_16x16x32_bf16 v[68:71], v[36:39], v[88:91], v[68:71]
    s_waitcnt lgkmcnt(7) vmcnt(1)
    v_mfma_f32_16x16x32_bf16 v[56:59], v[40:43], v[72:75], v[56:59]
    v_mfma_f32_16x16x32_bf16 v[60:63], v[44:47], v[72:75], v[60:63]
    v_mfma_f32_16x16x32_bf16 v[64:67], v[48:51], v[72:75], v[64:67]
    v_mfma_f32_16x16x32_bf16 v[68:71], v[52:55], v[72:75], v[68:71]
    v_and_b32 v2, 15, v1
    v_mul_u32_u24 v2, 2064, v2
    v_lshrrev_b32 v93, 4, v1
    v_lshl_add_u32 v2, v93, 6, v2
    s_lshl_b32 s37, s3, 8
    s_add_u32 s37, s37, 98304
    v_add_u32 v2, s37, v2
    s_mov_b32 s42, 0x00ff00ff
    s_mov_b32 s43, 0x00ff00ff
    s_mov_b64 exec, s[42:43]
    ds_write_b128 v2, v[56:59] offset:0
    ds_write_b128 v2, v[60:63] offset:16
    ds_write_b128 v2, v[64:67] offset:32
    ds_write_b128 v2, v[68:71] offset:48
    s_mov_b64 exec, -1
    s_mul_i32 s37, s3, 2064
    s_add_u32 s37, s37, 98304
    v_add_u32 v2, s37, v94
    s_bfe_u32 s56, s2, 0x10002
    s_mul_i32 s56, s56, 7
    s_lshr_b32 s36, s2, 5
    s_add_u32 s56, s56, s36
    s_lshl_b32 s56, s56, 3
    s_add_u32 s56, s56, s3
    s_lshl_b32 s56, s56, 15
    s_add_u32 s56, s56, 0x950000
    s_cmp_lg_u32 s3, 0
    s_cbranch_scc1 k2_pd
    s_mov_b32 s36, 200000
    s_mov_b64 exec, 0xffff
k2_pl:
    s_waitcnt vmcnt(0)
    v_cmp_ne_u32 vcc, 16, v251
    s_cbranch_vccz k2_pd
    buffer_load_dword v251, v250, s[4:7], s57 offen sc0 sc1
    s_sub_u32 s36, s36, 1
    s_cmp_lg_u32 s36, 0
    s_cbranch_scc1 k2_pl
k2_pd:
    s_mov_b64 exec, -1
    s_waitcnt lgkmcnt(0)
    s_barrier
    ds_read_b128 v[24:27], v2
    ds_read_b128 v[28:31], v2 offset:16
    buffer_load_dwordx4 v[128:131], v3, s[4:7], s56 offen offset:0
    buffer_load_dwordx4 v[132:135], v3, s[4:7], s56 offen offset:1024
    buffer_load_dwordx4 v[136:139], v3, s[4:7], s56 offen offset:2048
    buffer_load_dwordx4 v[140:143], v3, s[4:7], s56 offen offset:3072
    s_add_u32 s56, s56, 4096
    buffer_load_dwordx4 v[144:147], v3, s[4:7], s56 offen offset:0
    buffer_load_dwordx4 v[148:151], v3, s[4:7], s56 offen offset:1024
    buffer_load_dwordx4 v[152:155], v3, s[4:7], s56 offen offset:2048
    buffer_load_dwordx4 v[156:159], v3, s[4:7], s56 offen offset:3072
    s_add_u32 s56, s56, 4096
    v_lshlrev_b32 v40, 16, v4
    v_and_b32 v41, 0xffff0000, v4
    v_lshlrev_b32 v42, 16, v5
    v_and_b32 v43, 0xffff0000, v5
    v_lshlrev_b32 v44, 16, v6
    v_and_b32 v45, 0xffff0000, v6
    v_lshlrev_b32 v46, 16, v7
    v_and_b32 v47, 0xffff0000, v7
    s_waitcnt lgkmcnt(0)
    v_fmac_f32 v40, v24, v160
    v_fmac_f32 v41, v25, v161
    v_fmac_f32 v42, v26, v162
    v_fmac_f32 v43, v27, v163
    v_fmac_f32 v44, v28, v164
    v_fmac_f32 v45, v29, v165
    v_fmac_f32 v46, v30, v166
    v_fmac_f32 v47, v31, v167
    v_cvt_pk_bf16_f32 v32, v40, v41
    v_cvt_pk_bf16_f32 v33, v42, v43
    v_cvt_pk_bf16_f32 v34, v44, v45
    v_cvt_pk_bf16_f32 v35, v46, v47
    v_lshlrev_b32 v24, 16, v32
    v_and_b32 v25, 0xffff0000, v32
    v_lshlrev_b32 v26, 16, v33
    v_and_b32 v27, 0xffff0000, v33
    v_lshlrev_b32 v28, 16, v34
    v_and_b32 v29, 0xffff0000, v34
    v_lshlrev_b32 v30, 16, v35
    v_and_b32 v31, 0xffff0000, v35
    s_lshl_b32 s36, s24, 10
    s_add_u32 s36, s36, 0x550000
    buffer_store_dwordx4 v[32:35], v3, s[4:7], s36 offen sc0 sc1
    v_add_f32 v40, v24, v25
    v_add_f32 v41, v26, v27
    v_add_f32 v42, v28, v29
    v_add_f32 v43, v30, v31
    v_add_f32 v40, v40, v41
    v_add_f32 v42, v42, v43
    v_add_f32 v40, v40, v42
    s_nop 1
    v_add_f32_dpp v40, v40, v40 quad_perm:[1,0,3,2] row_mask:0xf bank_mask:0xf
    s_nop 1
    v_add_f32_dpp v40, v40, v40 quad_perm:[2,3,0,1] row_mask:0xf bank_mask:0xf
    s_nop 1
    v_add_f32_dpp v40, v40, v40 row_half_mirror row_mask:0xf bank_mask:0xf
    s_nop 1
    v_add_f32_dpp v40, v40, v40 row_mirror row_mask:0xf bank_mask:0xf
    s_nop 1
    v_add_f32_dpp v40, v40, v40 row_bcast:15 row_mask:0xa bank_mask:0xf
    s_nop 1
    v_add_f32_dpp v40, v40, v40 row_bcast:31 row_mask:0xc bank_mask:0xf
    v_mul_f32 v40, 0x3b000000, v40
    s_nop 0
    v_readlane_b32 s44, v40, 63
    s_nop 1
    v_subrev_f32 v24, s44, v24
    v_subrev_f32 v25, s44, v25
    v_subrev_f32 v26, s44, v26
    v_subrev_f32 v27, s44, v27
    v_subrev_f32 v28, s44, v28
    v_subrev_f32 v29, s44, v29
    v_subrev_f32 v30, s44, v30
    v_subrev_f32 v31, s44, v31
    v_mul_f32 v40, v24, v24
    v_mul_f32 v41, v25, v25
    v_fmac_f32 v40, v26, v26
    v_fmac_f32 v41, v27, v27
    v_fmac_f32 v40, v28, v28
    v_fmac_f32 v41, v29, v29
    v_fmac_f32 v40, v30, v30
    v_fmac_f32 v41, v31, v31
    v_add_f32 v40, v40, v41
    s_nop 1
    v_add_f32_dpp v40, v40, v40 quad_perm:[1,0,3,2] row_mask:0xf bank_mask:0xf
    s_nop 1
    v_add_f32_dpp v40, v40, v40 quad_perm:[2,3,0,1] row_mask:0xf bank_mask:0xf
    s_nop 1
    v_add_f32_dpp v40, v40, v40 row_half_mirror row_mask:0xf bank_mask:0xf
    s_nop 1
    v_add_f32_dpp v40, v40, v40 row_mirror row_mask:0xf bank_mask:0xf
    s_nop 1
    v_add_f32_dpp v40, v40, v40 row_bcast:15 row_mask:0xa bank_mask:0xf
    s_nop 1
    v_add_f32_dpp v40, v40, v40 row_bcast:31 row_mask:0xc bank_mask:0xf
    v_mov_b32 v41, 0x3727c5ac
    v_fmac_f32 v41, 0x3b000000, v40
    v_rsq_f32 v41, v41
    v_mul_u32_u24 v2, 144, v1
    s_lshl_b32 s37, s3, 4
    v_readlane_b32 s44, v41, 63
    s_add_u32 s37, s37, 115712
    s_mul_i32 s27, s3, 1152
    s_add_u32 s27, s27, 115712
    v_mul_f32 v24, v24, v176
    v_mul_f32 v25, v25, v177
    v_mul_f32 v26, v26, v178
    v_mul_f32 v27, v27, v179
    v_mul_f32 v28, v28, v180
    v_mul_f32 v29, v29, v181
    v_mul_f32 v30, v30, v182
    v_mul_f32 v31, v31, v183
    v_fmac_f32 v168, s44, v24
    v_fmac_f32 v169, s44, v25
    v_fmac_f32 v170, s44, v26
    v_fmac_f32 v171, s44, v27
    v_fmac_f32 v172, s44, v28
    v_fmac_f32 v173, s44, v29
    v_fmac_f32 v174, s44, v30
    v_fmac_f32 v175, s44, v31
    v_cvt_pk_bf16_f32 v36, v168, v169
    v_cvt_pk_bf16_f32 v37, v170, v171
    v_cvt_pk_bf16_f32 v38, v172, v173
    v_cvt_pk_bf16_f32 v39, v174, v175
    v_add_u32 v2, s37, v2
    ds_write_b128 v2, v[36:39]
    v_add_u32 v2, s27, v3
    v_lshrrev_b32 v40, 3, v1
    v_lshl_add_u32 v2, v40, 4, v2
    v_lshlrev_b32 v40, 9, v40
    v_and_b32 v41, 7, v1
    v_lshl_add_u32 v40, v41, 4, v40
    s_lshl_b32 s37, s3, 12
    s_lshl_b32 s36, s3, 4
    s_sub_u32 s25, s25, s36
    s_add_u32 s25, s25, s37
    s_add_u32 s25, s25, 0x750000
    s_waitcnt lgkmcnt(0)
    s_barrier
    ds_read_b128 v[36:39], v2
    s_waitcnt lgkmcnt(0)
    buffer_store_dwordx4 v[36:39], v40, s[4:7], s25 offen sc0 sc1
    s_load_dwordx2 s[8:9], s[0:1], 88
    s_lshl_b32 s36, s24, 4
    s_add_u32 s36, s36, 0x10000
    v_mov_b32 v40, 1
    s_cmp_eq_u32 s3, 0
    s_cselect_b64 s[42:43], 1, 0
    s_waitcnt vmcnt(0)
    s_barrier
    s_mov_b64 exec, s[42:43]
    buffer_store_dword v40, v1, s[4:7], s36 offen sc0 sc1
    s_mov_b64 exec, -1
    s_and_b32 s20, s2, 3
    s_lshl_b32 s20, s20, 2
    s_bfe_u32 s21, s2, 0x20003
    s_add_u32 s20, s20, s21
    s_bfe_u32 s21, s2, 0x10002
    s_mul_i32 s21, s21, 7
    s_lshr_b32 s22, s2, 5
    s_add_u32 s21, s21, s22
    s_lshl_b32 s21, s21, 3
    s_add_u32 s21, s21, s3
    v_lshlrev_b32 v3, 4, v1
    v_add_u32 v4, 0x10000, v3
    s_lshl_b32 s22, s3, 10
    s_lshl_b32 s23, s20, 17
    s_add_u32 s23, s23, s22
    s_add_u32 s23, s23, 0x750000
    s_lshl_b32 s24, s21, 15
    s_add_u32 s24, s24, 0x950000
    s_lshl_b32 s25, s20, 2
    s_mul_i32 s25, s25, 114688
    s_lshl_b32 s26, s21, 10
    s_add_u32 s25, s25, s26
    s_add_u32 s25, s25, 0xe90000
    s_waitcnt lgkmcnt(0)
    s_mov_b32 s6, 0x1590000
    s_mov_b32 s7, 0x00020000
    s_mov_b32 s10, 0x200000
    s_mov_b32 s11, 0x00020000
    s_and_b32 s40, s2, 3
    s_lshl_b32 s40, s40, 3
    s_bfe_u32 s41, s2, 0x20003
    s_add_u32 s40, s40, s41
    s_and_b32 s41, s2, 4
    s_add_u32 s40, s40, s41
    s_lshr_b32 s41, s2, 5
    v_add_u32 v7, 114688, v3
    s_mul_i32 s42, s3, 7168
    s_bfe_u32 s50, s2, 0x10002
    s_mul_i32 s50, s50, 57344
    s_add_u32 s42, s42, s50
    s_lshl_b32 s50, s50, 1
    s_sub_u32 s50, 57344, s50
    s_mul_i32 s32, s40, 229376
    s_add_u32 s32, s32, s42
    s_add_u32 s32, s32, 0xe90000
    s_mul_i32 s36, s41, 229376
    s_add_u32 s36, s36, s42
    s_add_u32 s36, s36, 0xcd0000
    s_add_u32 s33, s32, 4096
    s_add_u32 s34, s32, s50
    s_add_u32 s35, s34, 4096
    s_add_u32 s37, s36, 4096
    s_add_u32 s38, s36, s50
    s_add_u32 s39, s38, 4096
    s_lshr_b32 s50, s2, 7
    s_mul_i32 s50, s50, 114688
    s_bfe_u32 s51, s2, 0x10006
    s_mul_i32 s51, s51, 3584
    s_add_u32 s50, s50, s51
    s_add_u32 s50, s50, s34
    s_lshr_b32 s43, s40, 1
    s_lshl_b32 s43, s43, 11
    s_add_u32 s43, s43, 0x8000
    s_lshl_b32 s44, s20, 11
    s_add_u32 s44, s44, 0x8000
    v_and_b32 v5, 31, v1
    v_lshlrev_b32 v5, 10, v5
    v_lshrrev_b32 v6, 5, v1
    v_lshl_add_u32 v5, v6, 5, v5
    v_lshlrev_b32 v6, 6, v6
    s_lshl_b32 s45, s40, 1
    s_bfe_u32 s46, s3, 0x10001
    s_add_u32 s45, s45, s46
    s_lshl_b32 s45, s45, 15
    s_lshl_b32 s46, s41, 1
    s_lshr_b32 s47, s3, 2
    s_add_u32 s46, s46, s47
    s_lshl_b32 s46, s46, 2
    s_and_b32 s47, s3, 1
    s_add_u32 s46, s46, s47
    s_lshl_b32 s47, s46, 4
    s_add_u32 s45, s45, s47
    s_lshl_b32 s46, s46, 5
    s_add_u32 s46, s46, 10240
    s_add_u32 s47, s45, 0x550000
    s_cmp_ge_u32 s2, 224
    s_cbranch_scc1 k3_np
    s_add_u32 s24, s24, 8192
    s_cmp_eq_u32 s3, 0
    s_cbranch_scc1 k3_hp
    s_barrier
    s_branch k3_hg
k3_hp:
    s_lshl_b32 s48, s20, 11
    s_add_u32 s48, s48, 0x10000
    s_mov_b32 s49, 200000
    v_and_b32 v10, 15, v1
    v_lshlrev_b32 v10, 7, v10
k3_hl:
    buffer_load_dword v11, v10, s[4:7], s48 offen sc0 sc1
    s_sub_u32 s49, s49, 1
    s_cmp_eq_u32 s49, 0
    s_cbranch_scc1 k3_hd
    s_waitcnt vmcnt(0)
    v_cmp_eq_u32 vcc, 0, v11
    s_cbranch_vccnz k3_hl
k3_hd:
    s_waitcnt vmcnt(0)
    s_barrier
k3_hg:
    s_add_u32 m0, s22, 0
    s_add_u32 s26, s23, 0
    buffer_load_dwordx4 v3, s[4:7], s26 offen lds
    s_add_u32 m0, s22, 32768
    s_add_u32 s26, s23, 32768
    buffer_load_dwordx4 v3, s[4:7], s26 offen lds
    s_add_u32 m0, s22, 65536
    s_add_u32 s26, s23, 65536
    buffer_load_dwordx4 v3, s[4:7], s26 offen lds
    s_add_u32 m0, s22, 8192
    s_add_u32 s26, s23, 8192
    buffer_load_dwordx4 v3, s[4:7], s26 offen lds
    s_waitcnt vmcnt(1)
    s_barrier
    ds_read_b128 v[8:11], v3 offset:0
    ds_read_b128 v[12:15], v3 offset:32768
    ds_read_b128 v[16:19], v4 offset:0
    ds_read_b128 v[20:23], v3 offset:1024
    ds_read_b128 v[24:27], v3 offset:33792
    ds_read_b128 v[28:31], v4 offset:1024
    s_waitcnt lgkmcnt(5)
    v_mfma_f32_32x32x16_bf16 v[64:79], v[128:131], v[8:11], 0
    s_add_u32 m0, s22, 40960
    s_add_u32 s26, s23, 40960
    buffer_load_dwordx4 v3, s[4:7], s26 offen lds
    s_waitcnt lgkmcnt(4)
    v_mfma_f32_32x32x16_bf16 v[80:95], v[128:131], v[12:15], 0
    s_waitcnt lgkmcnt(3)
    v_mfma_f32_32x32x16_bf16 v[96:111], v[128:131], v[16:19], 0
    ds_read_b128 v[8:11], v3 offset:2048
    ds_read_b128 v[12:15], v3 offset:34816
    ds_read_b128 v[16:19], v4 offset:2048
    s_waitcnt lgkmcnt(5)
    v_mfma_f32_32x32x16_bf16 v[64:79], v[132:135], v[20:23], v[64:79]
    s_add_u32 m0, s22, 73728
    s_add_u32 s26, s23, 73728
    buffer_load_dwordx4 v3, s[4:7], s26 offen lds
    s_waitcnt lgkmcnt(4)
    v_mfma_f32_32x32x16_bf16 v[80:95], v[132:135], v[24:27], v[80:95]
    buffer_load_dwordx4 v[160:163], v3, s[4:7], s24 offen offset:0
    s_waitcnt lgkmcnt(3)
    v_mfma_f32_32x32x16_bf16 v[96:111], v[132:135], v[28:31], v[96:111]
    ds_read_b128 v[20:23], v3 offset:3072
    ds_read_b128 v[24:27], v3 offset:35840
    ds_read_b128 v[28:31], v4 offset:3072
    s_waitcnt lgkmcnt(5)
    v_mfma_f32_32x32x16_bf16 v[64:79], v[136:139], v[8:11], v[64:79]
    buffer_load_dwordx4 v[164:167], v3, s[4:7], s24 offen offset:1024
    s_waitcnt lgkmcnt(4)
    v_mfma_f32_32x32x16_bf16 v[80:95], v[136:139], v[12:15], v[80:95]
    s_waitcnt lgkmcnt(3)
    v_mfma_f32_32x32x16_bf16 v[96:111], v[136:139], v[16:19], v[96:111]
    ds_read_b128 v[8:11], v3 offset:4096
    ds_read_b128 v[12:15], v3 offset:36864
    ds_read_b128 v[16:19], v4 offset:4096
    s_waitcnt lgkmcnt(5)
    v_mfma_f32_32x32x16_bf16 v[64:79], v[140:143], v[20:23], v[64:79]
    buffer_load_dwordx4 v[168:171], v3, s[4:7], s24 offen offset:2048
    s_waitcnt lgkmcnt(4)
    v_mfma_f32_32x32x16_bf16 v[80:95], v[140:143], v[24:27], v[80:95]
    buffer_load_dwordx4 v[172:175], v3, s[4:7], s24 offen offset:3072
    s_add_u32 s24, s24, 4096
    s_waitcnt lgkmcnt(3)
    v_mfma_f32_32x32x16_bf16 v[96:111], v[140:143], v[28:31], v[96:111]
    ds_read_b128 v[20:23], v3 offset:5120
    ds_read_b128 v[24:27], v3 offset:37888
    ds_read_b128 v[28:31], v4 offset:5120
    s_waitcnt lgkmcnt(5)
    v_mfma_f32_32x32x16_bf16 v[64:79], v[144:147], v[8:11], v[64:79]
    buffer_load_dwordx4 v[176:179], v3, s[4:7], s24 offen offset:0
    s_waitcnt lgkmcnt(4)
    v_mfma_f32_32x32x16_bf16 v[80:95], v[144:147], v[12:15], v[80:95]
    s_waitcnt lgkmcnt(3)
    v_mfma_f32_32x32x16_bf16 v[96:111], v[144:147], v[16:19], v[96:111]
    ds_read_b128 v[8:11], v3 offset:6144
    ds_read_b128 v[12:15], v3 offset:38912
    ds_read_b128 v[16:19], v4 offset:6144
    s_waitcnt lgkmcnt(5)
    v_mfma_f32_32x32x16_bf16 v[64:79], v[148:151], v[20:23], v[64:79]
    buffer_load_dwordx4 v[180:183], v3, s[4:7], s24 offen offset:1024
    s_waitcnt lgkmcnt(4)
    v_mfma_f32_32x32x16_bf16 v[80:95], v[148:151], v[24:27], v[80:95]
    buffer_load_dwordx4 v[184:187], v3, s[4:7], s24 offen offset:2048
    s_waitcnt lgkmcnt(3)
    v_mfma_f32_32x32x16_bf16 v[96:111], v[148:151], v[28:31], v[96:111]
    ds_read_b128 v[20:23], v3 offset:7168
    ds_read_b128 v[24:27], v3 offset:39936
    ds_read_b128 v[28:31], v4 offset:7168
    s_waitcnt lgkmcnt(5)
    v_mfma_f32_32x32x16_bf16 v[64:79], v[152:155], v[8:11], v[64:79]
    buffer_load_dwordx4 v[188:191], v3, s[4:7], s24 offen offset:3072
    s_add_u32 s24, s24, 4096
    s_waitcnt lgkmcnt(4)
    v_mfma_f32_32x32x16_bf16 v[80:95], v[152:155], v[12:15], v[80:95]
    s_waitcnt lgkmcnt(3)
    v_mfma_f32_32x32x16_bf16 v[96:111], v[152:155], v[16:19], v[96:111]
    s_waitcnt lgkmcnt(2)
    v_mfma_f32_32x32x16_bf16 v[64:79], v[156:159], v[20:23], v[64:79]
    s_add_u32 m0, s22, 16384
    s_add_u32 s26, s23, 16384
    buffer_load_dwordx4 v3, s[4:7], s26 offen lds
    s_waitcnt lgkmcnt(1)
    v_mfma_f32_32x32x16_bf16 v[80:95], v[156:159], v[24:27], v[80:95]
    s_add_u32 m0, s22, 49152
    s_add_u32 s26, s23, 49152
    buffer_load_dwordx4 v3, s[4:7], s26 offen lds
    s_waitcnt lgkmcnt(0)
    v_mfma_f32_32x32x16_bf16 v[96:111], v[156:159], v[28:31], v[96:111]
    s_waitcnt vmcnt(10)
    s_barrier
    ds_read_b128 v[8:11], v3 offset:8192
    ds_read_b128 v[12:15], v3 offset:40960
    ds_read_b128 v[16:19], v4 offset:8192
    ds_read_b128 v[20:23], v3 offset:9216
    ds_read_b128 v[24:27], v3 offset:41984
    ds_read_b128 v[28:31], v4 offset:9216
    s_waitcnt vmcnt(9)
    s_waitcnt lgkmcnt(5)
    v_mfma_f32_32x32x16_bf16 v[64:79], v[160:163], v[8:11], v[64:79]
    s_add_u32 m0, s22, 81920
    s_add_u32 s26, s23, 81920
    buffer_load_dwordx4 v3, s[4:7], s26 offen lds
    s_waitcnt lgkmcnt(4)
    v_mfma_f32_32x32x16_bf16 v[80:95], v[160:163], v[12:15], v[80:95]
    s_waitcnt lgkmcnt(3)
    v_mfma_f32_32x32x16_bf16 v[96:111], v[160:163], v[16:19], v[96:111]
    ds_read_b128 v[8:11], v3 offset:10240
    ds_read_b128 v[12:15], v3 offset:43008
    ds_read_b128 v[16:19], v4 offset:10240
    s_waitcnt vmcnt(9)
    s_waitcnt lgkmcnt(5)
    v_mfma_f32_32x32x16_bf16 v[64:79], v[164:167], v[20:23], v[64:79]
    buffer_load_dwordx4 v[192:195], v3, s[4:7], s24 offen offset:0
    s_waitcnt lgkmcnt(4)
    v_mfma_f32_32x32x16_bf16 v[80:95], v[164:167], v[24:27], v[80:95]
    buffer_load_dwordx4 v[196:199], v3, s[4:7], s24 offen offset:1024
    s_waitcnt lgkmcnt(3)
    v_mfma_f32_32x32x16_bf16 v[96:111], v[164:167], v[28:31], v[96:111]
    ds_read_b128 v[20:23], v3 offset:11264
    ds_read_b128 v[24:27], v3 offset:44032
    ds_read_b128 v[28:31], v4 offset:11264
    s_waitcnt vmcnt(10)
    s_waitcnt lgkmcnt(5)
    v_mfma_f32_32x32x16_bf16 v[64:79], v[168:171], v[8:11], v[64:79]
    buffer_load_dwordx4 v[200:203], v3, s[4:7], s24 offen offset:2048
    s_waitcnt lgkmcnt(4)
    v_mfma_f32_32x32x16_bf16 v[80:95], v[168:171], v[12:15], v[80:95]
    s_waitcnt lgkmcnt(3)
    v_mfma_f32_32x32x16_bf16 v[96:111], v[168:171], v[16:19], v[96:111]
    ds_read_b128 v[8:11], v3 offset:12288
    ds_read_b128 v[12:15], v3 offset:45056
    ds_read_b128 v[16:19], v4 offset:12288
    s_waitcnt vmcnt(10)
    s_waitcnt lgkmcnt(5)
    v_mfma_f32_32x32x16_bf16 v[64:79], v[172:175], v[20:23], v[64:79]
    buffer_load_dwordx4 v[204:207], v3, s[4:7], s24 offen offset:3072
    s_add_u32 s24, s24, 4096
    s_waitcnt lgkmcnt(4)
    v_mfma_f32_32x32x16_bf16 v[80:95], v[172:175], v[24:27], v[80:95]
    buffer_load_dwordx4 v[208:211], v3, s[4:7], s24 offen offset:0
    s_waitcnt lgkmcnt(3)
    v_mfma_f32_32x32x16_bf16 v[96:111], v[172:175], v[28:31], v[96:111]
    ds_read_b128 v[20:23], v3 offset:13312
    ds_read_b128 v[24:27], v3 offset:46080
    ds_read_b128 v[28:31], v4 offset:13312
    s_waitcnt vmcnt(11)
    s_waitcnt lgkmcnt(5)
    v_mfma_f32_32x32x16_bf16 v[64:79], v[176:179], v[8:11], v[64:79]
    buffer_load_dwordx4 v[212:215], v3, s[4:7], s24 offen offset:1024
    s_waitcnt lgkmcnt(4)
    v_mfma_f32_32x32x16_bf16 v[80:95], v[176:179], v[12:15], v[80:95]
    s_waitcnt lgkmcnt(3)
    v_mfma_f32_32x32x16_bf16 v[96:111], v[176:179], v[16:19], v[96:111]
    ds_read_b128 v[8:11], v3 offset:14336
    ds_read_b128 v[12:15], v3 offset:47104
    ds_read_b128 v[16:19], v4 offset:14336
    s_waitcnt vmcnt(11)
    s_waitcnt lgkmcnt(5)
    v_mfma_f32_32x32x16_bf16 v[64:79], v[180:183], v[20:23], v[64:79]
    buffer_load_dwordx4 v[216:219], v3, s[4:7], s24 offen offset:2048
    s_waitcnt lgkmcnt(4)
    v_mfma_f32_32x32x16_bf16 v[80:95], v[180:183], v[24:27], v[80:95]
    buffer_load_dwordx4 v[220:223], v3, s[4:7], s24 offen offset:3072
    s_add_u32 s24, s24, 4096
    s_waitcnt lgkmcnt(3)
    v_mfma_f32_32x32x16_bf16 v[96:111], v[180:183], v[28:31], v[96:111]
    ds_read_b128 v[20:23], v3 offset:15360
    ds_read_b128 v[24:27], v3 offset:48128
    ds_read_b128 v[28:31], v4 offset:15360
    s_waitcnt vmcnt(12)
    s_waitcnt lgkmcnt(5)
    v_mfma_f32_32x32x16_bf16 v[64:79], v[184:187], v[8:11], v[64:79]
    s_add_u32 m0, s22, 24576
    s_add_u32 s26, s23, 24576
    buffer_load_dwordx4 v3, s[4:7], s26 offen lds
    s_waitcnt lgkmcnt(4)
    v_mfma_f32_32x32x16_bf16 v[80:95], v[184:187], v[12:15], v[80:95]
    s_waitcnt lgkmcnt(3)
    v_mfma_f32_32x32x16_bf16 v[96:111], v[184:187], v[16:19], v[96:111]
    s_waitcnt vmcnt(12)
    s_waitcnt lgkmcnt(2)
    v_mfma_f32_32x32x16_bf16 v[64:79], v[188:191], v[20:23], v[64:79]
    s_add_u32 m0, s22, 57344
    s_add_u32 s26, s23, 57344
    buffer_load_dwordx4 v3, s[4:7], s26 offen lds
    s_waitcnt lgkmcnt(1)
    v_mfma_f32_32x32x16_bf16 v[80:95], v[188:191], v[24:27], v[80:95]
    s_add_u32 m0, s22, 90112
    s_add_u32 s26, s23, 90112
    buffer_load_dwordx4 v3, s[4:7], s26 offen lds
    s_waitcnt lgkmcnt(0)
    v_mfma_f32_32x32x16_bf16 v[96:111], v[188:191], v[28:31], v[96:111]
    s_waitcnt vmcnt(11)
    s_barrier
    ds_read_b128 v[8:11], v3 offset:16384
    ds_read_b128 v[12:15], v3 offset:49152
    ds_read_b128 v[16:19], v4 offset:16384
    ds_read_b128 v[20:23], v3 offset:17408
    ds_read_b128 v[24:27], v3 offset:50176
    ds_read_b128 v[28:31], v4 offset:17408
    s_waitcnt vmcnt(10)
    s_waitcnt lgkmcnt(5)
    v_mfma_f32_32x32x16_bf16 v[64:79], v[192:195], v[8:11], v[64:79]
    buffer_load_dwordx4 v[224:227], v3, s[4:7], s24 offen offset:0
    s_waitcnt lgkmcnt(4)
    v_mfma_f32_32x32x16_bf16 v[80:95], v[192:195], v[12:15], v[80:95]
    s_waitcnt lgkmcnt(3)
    v_mfma_f32_32x32x16_bf16 v[96:111], v[192:195], v[16:19], v[96:111]
    ds_read_b128 v[8:11], v3 offset:18432
    ds_read_b128 v[12:15], v3 offset:51200
    ds_read_b128 v[16:19], v4 offset:18432
    s_waitcnt vmcnt(10)
    s_waitcnt lgkmcnt(5)
    v_mfma_f32_32x32x16_bf16 v[64:79], v[196:199], v[20:23], v[64:79]
    buffer_load_dwordx4 v[228:231], v3, s[4:7], s24 offen offset:1024
    s_waitcnt lgkmcnt(4)
    v_mfma_f32_32x32x16_bf16 v[80:95], v[196:199], v[24:27], v[80:95]
    buffer_load_dwordx4 v[232:235], v3, s[4:7], s24 offen offset:2048
    s_waitcnt lgkmcnt(3)
    v_mfma_f32_32x32x16_bf16 v[96:111], v[196:199], v[28:31], v[96:111]
    ds_read_b128 v[20:23], v3 offset:19456
    ds_read_b128 v[24:27], v3 offset:52224
    ds_read_b128 v[28:31], v4 offset:19456
    s_waitcnt vmcnt(11)
    s_waitcnt lgkmcnt(5)
    v_mfma_f32_32x32x16_bf16 v[64:79], v[200:203], v[8:11], v[64:79]
    buffer_load_dwordx4 v[236:239], v3, s[4:7], s24 offen offset:3072
    s_add_u32 s24, s24, 4096
    s_waitcnt lgkmcnt(4)
    v_mfma_f32_32x32x16_bf16 v[80:95], v[200:203], v[12:15], v[80:95]
    s_waitcnt lgkmcnt(3)
    v_mfma_f32_32x32x16_bf16 v[96:111], v[200:203], v[16:19], v[96:111]
    ds_read_b128 v[8:11], v3 offset:20480
    ds_read_b128 v[12:15], v3 offset:53248
    ds_read_b128 v[16:19], v4 offset:20480
    s_waitcnt vmcnt(11)
    s_waitcnt lgkmcnt(5)
    v_mfma_f32_32x32x16_bf16 v[64:79], v[204:207], v[20:23], v[64:79]
    buffer_load_dwordx4 v[240:243], v3, s[4:7], s24 offen offset:0
    s_waitcnt lgkmcnt(4)
    v_mfma_f32_32x32x16_bf16 v[80:95], v[204:207], v[24:27], v[80:95]
    buffer_load_dwordx4 v[244:247], v3, s[4:7], s24 offen offset:1024
    s_waitcnt lgkmcnt(3)
    v_mfma_f32_32x32x16_bf16 v[96:111], v[204:207], v[28:31], v[96:111]
    ds_read_b128 v[20:23], v3 offset:21504
    ds_read_b128 v[24:27], v3 offset:54272
    ds_read_b128 v[28:31], v4 offset:21504
    s_waitcnt vmcnt(12)
    s_waitcnt lgkmcnt(5)
    v_mfma_f32_32x32x16_bf16 v[64:79], v[208:211], v[8:11], v[64:79]
    buffer_load_dwordx4 v[248:251], v3, s[4:7], s24 offen offset:2048
    s_waitcnt lgkmcnt(4)
    v_mfma_f32_32x32x16_bf16 v[80:95], v[208:211], v[12:15], v[80:95]
    s_waitcnt lgkmcnt(3)
    v_mfma_f32_32x32x16_bf16 v[96:111], v[208:211], v[16:19], v[96:111]
    ds_read_b128 v[8:11], v3 offset:22528
    ds_read_b128 v[12:15], v3 offset:55296
    ds_read_b128 v[16:19], v4 offset:22528
    s_waitcnt vmcnt(12)
    s_waitcnt lgkmcnt(5)
    v_mfma_f32_32x32x16_bf16 v[64:79], v[212:215], v[20:23], v[64:79]
    buffer_load_dwordx4 v[252:255], v3, s[4:7], s24 offen offset:3072
    s_add_u32 s24, s24, 4096
    s_waitcnt lgkmcnt(4)
    v_mfma_f32_32x32x16_bf16 v[80:95], v[212:215], v[24:27], v[80:95]
    s_add_u32 m0, s22, 98304
    s_add_u32 s26, s23, 98304
    buffer_load_dwordx4 v3, s[4:7], s26 offen lds
    s_waitcnt lgkmcnt(3)
    v_mfma_f32_32x32x16_bf16 v[96:111], v[212:215], v[28:31], v[96:111]
    ds_read_b128 v[20:23], v3 offset:23552
    ds_read_b128 v[24:27], v3 offset:56320
    ds_read_b128 v[28:31], v4 offset:23552
    s_waitcnt vmcnt(13)
    s_waitcnt lgkmcnt(5)
    v_mfma_f32_32x32x16_bf16 v[64:79], v[216:219], v[8:11], v[64:79]
    s_add_u32 m0, s22, 106496
    s_add_u32 s26, s23, 106496
    buffer_load_dwordx4 v3, s[4:7], s26 offen lds
    s_waitcnt lgkmcnt(4)
    v_mfma_f32_32x32x16_bf16 v[80:95], v[216:219], v[12:15], v[80:95]
    s_waitcnt lgkmcnt(3)
    v_mfma_f32_32x32x16_bf16 v[96:111], v[216:219], v[16:19], v[96:111]
    s_waitcnt vmcnt(13)
    s_waitcnt lgkmcnt(2)
    v_mfma_f32_32x32x16_bf16 v[64:79], v[220:223], v[20:23], v[64:79]
    s_add_u32 m0, s22, 114688
    s_add_u32 s26, s23, 114688
    buffer_load_dwordx4 v3, s[4:7], s26 offen lds
    s_waitcnt lgkmcnt(1)
    v_mfma_f32_32x32x16_bf16 v[80:95], v[220:223], v[24:27], v[80:95]
    s_add_u32 m0, s22, 122880
    s_add_u32 s26, s23, 122880
    buffer_load_dwordx4 v3, s[4:7], s26 offen lds
    s_waitcnt lgkmcnt(0)
    v_mfma_f32_32x32x16_bf16 v[96:111], v[220:223], v[28:31], v[96:111]
    s_waitcnt vmcnt(12)
    s_barrier
    ds_read_b128 v[8:11], v3 offset:24576
    ds_read_b128 v[12:15], v3 offset:57344
    ds_read_b128 v[16:19], v4 offset:24576
    ds_read_b128 v[20:23], v3 offset:25600
    ds_read_b128 v[24:27], v3 offset:58368
    ds_read_b128 v[28:31], v4 offset:25600
    s_waitcnt vmcnt(11)
    s_waitcnt lgkmcnt(5)
    v_mfma_f32_32x32x16_bf16 v[64:79], v[224:227], v[8:11], v[64:79]
    s_waitcnt lgkmcnt(4)
    v_mfma_f32_32x32x16_bf16 v[80:95], v[224:227], v[12:15], v[80:95]
    s_waitcnt lgkmcnt(3)
    v_mfma_f32_32x32x16_bf16 v[96:111], v[224:227], v[16:19], v[96:111]
    ds_read_b128 v[8:11], v3 offset:26624
    ds_read_b128 v[12:15], v3 offset:59392
    ds_read_b128 v[16:19], v4 offset:26624
    s_waitcnt vmcnt(10)
    s_waitcnt lgkmcnt(5)
    v_mfma_f32_32x32x16_bf16 v[64:79], v[228:231], v[20:23], v[64:79]
    s_waitcnt lgkmcnt(4)
    v_mfma_f32_32x32x16_bf16 v[80:95], v[228:231], v[24:27], v[80:95]
    s_waitcnt lgkmcnt(3)
    v_mfma_f32_32x32x16_bf16 v[96:111], v[228:231], v[28:31], v[96:111]
    ds_read_b128 v[20:23], v3 offset:27648
    ds_read_b128 v[24:27], v3 offset:60416
    ds_read_b128 v[28:31], v4 offset:27648
    s_waitcnt vmcnt(9)
    s_waitcnt lgkmcnt(5)
    v_mfma_f32_32x32x16_bf16 v[64:79], v[232:235], v[8:11], v[64:79]
    s_waitcnt lgkmcnt(4)
    v_mfma_f32_32x32x16_bf16 v[80:95], v[232:235], v[12:15], v[80:95]
    s_waitcnt lgkmcnt(3)
    v_mfma_f32_32x32x16_bf16 v[96:111], v[232:235], v[16:19], v[96:111]
    ds_read_b128 v[8:11], v3 offset:28672
    ds_read_b128 v[12:15], v3 offset:61440
    ds_read_b128 v[16:19], v4 offset:28672
    s_waitcnt vmcnt(8)
    s_waitcnt lgkmcnt(5)
    v_mfma_f32_32x32x16_bf16 v[64:79], v[236:239], v[20:23], v[64:79]
    s_waitcnt lgkmcnt(4)
    v_mfma_f32_32x32x16_bf16 v[80:95], v[236:239], v[24:27], v[80:95]
    s_waitcnt lgkmcnt(3)
    v_mfma_f32_32x32x16_bf16 v[96:111], v[236:239], v[28:31], v[96:111]
    ds_read_b128 v[20:23], v3 offset:29696
    ds_read_b128 v[24:27], v3 offset:62464
    ds_read_b128 v[28:31], v4 offset:29696
    s_waitcnt vmcnt(7)
    s_waitcnt lgkmcnt(5)
    v_mfma_f32_32x32x16_bf16 v[64:79], v[240:243], v[8:11], v[64:79]
    s_waitcnt lgkmcnt(4)
    v_mfma_f32_32x32x16_bf16 v[80:95], v[240:243], v[12:15], v[80:95]
    s_waitcnt lgkmcnt(3)
    v_mfma_f32_32x32x16_bf16 v[96:111], v[240:243], v[16:19], v[96:111]
    ds_read_b128 v[8:11], v3 offset:30720
    ds_read_b128 v[12:15], v3 offset:63488
    ds_read_b128 v[16:19], v4 offset:30720
    s_waitcnt vmcnt(6)
    s_waitcnt lgkmcnt(5)
    v_mfma_f32_32x32x16_bf16 v[64:79], v[244:247], v[20:23], v[64:79]
    s_waitcnt lgkmcnt(4)
    v_mfma_f32_32x32x16_bf16 v[80:95], v[244:247], v[24:27], v[80:95]
    s_waitcnt lgkmcnt(3)
    v_mfma_f32_32x32x16_bf16 v[96:111], v[244:247], v[28:31], v[96:111]
    ds_read_b128 v[20:23], v3 offset:31744
    ds_read_b128 v[24:27], v3 offset:64512
    ds_read_b128 v[28:31], v4 offset:31744
    s_waitcnt vmcnt(5)
    s_waitcnt lgkmcnt(5)
    v_mfma_f32_32x32x16_bf16 v[64:79], v[248:251], v[8:11], v[64:79]
    s_waitcnt lgkmcnt(4)
    v_mfma_f32_32x32x16_bf16 v[80:95], v[248:251], v[12:15], v[80:95]
    s_waitcnt lgkmcnt(3)
    v_mfma_f32_32x32x16_bf16 v[96:111], v[248:251], v[16:19], v[96:111]
    s_waitcnt vmcnt(4)
    s_waitcnt lgkmcnt(2)
    v_mfma_f32_32x32x16_bf16 v[64:79], v[252:255], v[20:23], v[64:79]
    s_waitcnt lgkmcnt(1)
    v_mfma_f32_32x32x16_bf16 v[80:95], v[252:255], v[24:27], v[80:95]
    s_waitcnt lgkmcnt(0)
    v_mfma_f32_32x32x16_bf16 v[96:111], v[252:255], v[28:31], v[96:111]
    s_waitcnt vmcnt(0)
    s_barrier
    ds_read_b128 v[8:11], v4 offset:32768
    ds_read_b128 v[12:15], v4 offset:33792
    ds_read_b128 v[16:19], v4 offset:34816
    ds_read_b128 v[20:23], v4 offset:35840
    ds_read_b128 v[24:27], v4 offset:36864
    ds_read_b128 v[28:31], v4 offset:37888
    s_nop 1
    s_waitcnt lgkmcnt(5)
    v_mfma_f32_32x32x16_bf16 v[112:127], v[128:131], v[8:11], 0
    ds_read_b128 v[8:11], v4 offset:38912
    buffer_load_dwordx4 v[128:131], v3, s[4:7], s36 offen offset:0
    v_mul_f32 v32, 0xbfb8aa3b, v64
    v_mul_f32 v33, 0xbfb8aa3b, v65
    v_mul_f32 v34, 0xbfb8aa3b, v66
    v_mul_f32 v35, 0xbfb8aa3b, v67
    v_mul_f32 v36, 0xbfb8aa3b, v68
    s_waitcnt lgkmcnt(5)
    v_mfma_f32_32x32x16_bf16 v[112:127], v[132:135], v[12:15], v[112:127]
    ds_read_b128 v[12:15], v4 offset:39936
    v_mul_f32 v37, 0xbfb8aa3b, v69
    v_mul_f32 v38, 0xbfb8aa3b, v70
    v_mul_f32 v39, 0xbfb8aa3b, v71
    v_exp_f32 v32, v32
    v_exp_f32 v33, v33
    s_waitcnt lgkmcnt(5)
    v_mfma_f32_32x32x16_bf16 v[112:127], v[136:139], v[16:19], v[112:127]
    ds_read_b128 v[16:19], v4 offset:40960
    buffer_load_dwordx4 v[132:135], v7, s[4:7], s36 offen offset:0
    v_exp_f32 v34, v34
    v_exp_f32 v35, v35
    v_exp_f32 v36, v36
    v_exp_f32 v37, v37
    v_exp_f32 v38, v38
    s_waitcnt lgkmcnt(5)
    v_mfma_f32_32x32x16_bf16 v[112:127], v[140:143], v[20:23], v[112:127]
    ds_read_b128 v[20:23], v4 offset:41984
    v_exp_f32 v39, v39
    v_add_f32 v32, 1.0, v32
    v_add_f32 v33, 1.0, v33
    v_add_f32 v34, 1.0, v34
    v_add_f32 v35, 1.0, v35
    s_waitcnt lgkmcnt(5)
    v_mfma_f32_32x32x16_bf16 v[112:127], v[144:147], v[24:27], v[112:127]
    ds_read_b128 v[24:27], v4 offset:43008
    buffer_load_dwordx4 v[136:139], v3, s[4:7], s36 offen offset:1024
    v_add_f32 v36, 1.0, v36
    v_add_f32 v37, 1.0, v37
    v_add_f32 v38, 1.0, v38
    v_add_f32 v39, 1.0, v39
    v_rcp_f32 v32, v32
    s_waitcnt lgkmcnt(5)
    v_mfma_f32_32x32x16_bf16 v[112:127], v[148:151], v[28:31], v[112:127]
    ds_read_b128 v[28:31], v4 offset:44032
    v_rcp_f32 v33, v33
    v_rcp_f32 v34, v34
    v_rcp_f32 v35, v35
    v_rcp_f32 v36, v36
    v_rcp_f32 v37, v37
    s_waitcnt lgkmcnt(5)
    v_mfma_f32_32x32x16_bf16 v[112:127], v[152:155], v[8:11], v[112:127]
    ds_read_b128 v[8:11], v4 offset:45056
    buffer_load_dwordx4 v[140:143], v7, s[4:7], s36 offen offset:1024
    v_rcp_f32 v38, v38
    v_rcp_f32 v39, v39
    v_mul_f32 v64, v64, v72
    v_mul_f32 v65, v65, v73
    v_mul_f32 v66, v66, v74
    s_waitcnt lgkmcnt(5)
    v_mfma_f32_32x32x16_bf16 v[112:127], v[156:159], v[12:15], v[112:127]
    ds_read_b128 v[12:15], v4 offset:46080
    v_mul_f32 v67, v67, v75
    v_mul_f32 v68, v68, v76
    v_mul_f32 v69, v69, v77
    v_mul_f32 v70, v70, v78
    v_mul_f32 v71, v71, v79
    s_waitcnt lgkmcnt(5)
    v_mfma_f32_32x32x16_bf16 v[112:127], v[160:163], v[16:19], v[112:127]
    ds_read_b128 v[16:19], v4 offset:47104
    buffer_load_dwordx4 v[144:147], v3, s[4:7], s36 offen offset:2048
    v_mul_f32 v32, v32, v64
    v_mul_f32 v33, v33, v65
    v_mul_f32 v34, v34, v66
    v_mul_f32 v35, v35, v67
    v_mul_f32 v36, v36, v68
    s_waitcnt lgkmcnt(5)
    v_mfma_f32_32x32x16_bf16 v[112:127], v[164:167], v[20:23], v[112:127]
    ds_read_b128 v[20:23], v4 offset:48128
    v_mul_f32 v37, v37, v69
    v_mul_f32 v38, v38, v70
    v_mul_f32 v39, v39, v71
    v_cvt_pk_bf16_f32 v40, v32, v33
    v_cvt_pk_bf16_f32 v41, v34, v35
    s_waitcnt lgkmcnt(5)
    v_mfma_f32_32x32x16_bf16 v[112:127], v[168:171], v[24:27], v[112:127]
    ds_read_b128 v[24:27], v4 offset:49152
    buffer_load_dwordx4 v[148:151], v7, s[4:7], s36 offen offset:2048
    v_cvt_pk_bf16_f32 v42, v36, v37
    v_cvt_pk_bf16_f32 v43, v38, v39
    buffer_store_dwordx4 v[40:43], v3, s[4:7], s25 offen sc0 sc1
    s_add_u32 s25, s25, 114688
    v_mul_f32 v32, 0xbfb8aa3b, v80
    v_mul_f32 v33, 0xbfb8aa3b, v81
    s_waitcnt lgkmcnt(5)
    v_mfma_f32_32x32x16_bf16 v[112:127], v[172:175], v[28:31], v[112:127]
    ds_read_b128 v[28:31], v4 offset:50176
    v_mul_f32 v34, 0xbfb8aa3b, v82
    v_mul_f32 v35, 0xbfb8aa3b, v83
    v_mul_f32 v36, 0xbfb8aa3b, v84
    v_mul_f32 v37, 0xbfb8aa3b, v85
    v_mul_f32 v38, 0xbfb8aa3b, v86
    s_waitcnt lgkmcnt(5)
    v_mfma_f32_32x32x16_bf16 v[112:127], v[176:179], v[8:11], v[112:127]
    ds_read_b128 v[8:11], v4 offset:51200
    buffer_load_dwordx4 v[152:155], v3, s[4:7], s36 offen offset:3072
    v_mul_f32 v39, 0xbfb8aa3b, v87
    v_exp_f32 v32, v32
    v_exp_f32 v33, v33
    v_exp_f32 v34, v34
    v_exp_f32 v35, v35
    s_waitcnt lgkmcnt(5)
    v_mfma_f32_32x32x16_bf16 v[112:127], v[180:183], v[12:15], v[112:127]
    ds_read_b128 v[12:15], v4 offset:52224
    v_exp_f32 v36, v36
    v_exp_f32 v37, v37
    v_exp_f32 v38, v38
    v_exp_f32 v39, v39
    v_add_f32 v32, 1.0, v32
    s_waitcnt lgkmcnt(5)
    v_mfma_f32_32x32x16_bf16 v[112:127], v[184:187], v[16:19], v[112:127]
    ds_read_b128 v[16:19], v4 offset:53248
    buffer_load_dwordx4 v[156:159], v7, s[4:7], s36 offen offset:3072
    v_add_f32 v33, 1.0, v33
    v_add_f32 v34, 1.0, v34
    v_add_f32 v35, 1.0, v35
    v_add_f32 v36, 1.0, v36
    v_add_f32 v37, 1.0, v37
    s_waitcnt lgkmcnt(5)
    v_mfma_f32_32x32x16_bf16 v[112:127], v[188:191], v[20:23], v[112:127]
    ds_read_b128 v[20:23], v4 offset:54272
    v_add_f32 v38, 1.0, v38
    v_add_f32 v39, 1.0, v39
    v_rcp_f32 v32, v32
    v_rcp_f32 v33, v33
    v_rcp_f32 v34, v34
    s_waitcnt lgkmcnt(5)
    v_mfma_f32_32x32x16_bf16 v[112:127], v[192:195], v[24:27], v[112:127]
    ds_read_b128 v[24:27], v4 offset:55296
    buffer_load_dwordx4 v[160:163], v3, s[4:7], s37 offen offset:0
    v_rcp_f32 v35, v35
    v_rcp_f32 v36, v36
    v_rcp_f32 v37, v37
    v_rcp_f32 v38, v38
    v_rcp_f32 v39, v39
    s_waitcnt lgkmcnt(5)
    v_mfma_f32_32x32x16_bf16 v[112:127], v[196:199], v[28:31], v[112:127]
    ds_read_b128 v[28:31], v4 offset:56320
    v_mul_f32 v80, v80, v88
    v_mul_f32 v81, v81, v89
    v_mul_f32 v82, v82, v90
    v_mul_f32 v83, v83, v91
    v_mul_f32 v84, v84, v92
    s_waitcnt lgkmcnt(5)
    v_mfma_f32_32x32x16_bf16 v[112:127], v[200:203], v[8:11], v[112:127]
    ds_read_b128 v[8:11], v4 offset:57344
    buffer_load_dwordx4 v[164:167], v7, s[4:7], s37 offen offset:0
    v_mul_f32 v85, v85, v93
    v_mul_f32 v86, v86, v94
    v_mul_f32 v87, v87, v95
    v_mul_f32 v32, v32, v80
    v_mul_f32 v33, v33, v81
    s_waitcnt lgkmcnt(5)
    v_mfma_f32_32x32x16_bf16 v[112:127], v[204:207], v[12:15], v[112:127]
    ds_read_b128 v[12:15], v4 offset:58368
    v_mul_f32 v34, v34, v82
    v_mul_f32 v35, v35, v83
    v_mul_f32 v36, v36, v84
    v_mul_f32 v37, v37, v85
    v_mul_f32 v38, v38, v86
    s_waitcnt lgkmcnt(5)
    v_mfma_f32_32x32x16_bf16 v[112:127], v[208:211], v[16:19], v[112:127]
    ds_read_b128 v[16:19], v4 offset:59392
    buffer_load_dwordx4 v[168:171], v3, s[4:7], s37 offen offset:1024
    v_mul_f32 v39, v39, v87
    v_cvt_pk_bf16_f32 v44, v32, v33
    v_cvt_pk_bf16_f32 v45, v34, v35
    v_cvt_pk_bf16_f32 v46, v36, v37
    v_cvt_pk_bf16_f32 v47, v38, v39
    s_waitcnt lgkmcnt(5)
    v_mfma_f32_32x32x16_bf16 v[112:127], v[212:215], v[20:23], v[112:127]
    ds_read_b128 v[20:23], v4 offset:60416
    buffer_store_dwordx4 v[44:47], v3, s[4:7], s25 offen sc0 sc1
    s_add_u32 s25, s25, 114688
    v_mul_f32 v32, 0xbfb8aa3b, v96
    v_mul_f32 v33, 0xbfb8aa3b, v97
    v_mul_f32 v34, 0xbfb8aa3b, v98
    v_mul_f32 v35, 0xbfb8aa3b, v99
    s_waitcnt lgkmcnt(5)
    v_mfma_f32_32x32x16_bf16 v[112:127], v[216:219], v[24:27], v[112:127]
    ds_read_b128 v[24:27], v4 offset:61440
    buffer_load_dwordx4 v[172:175], v7, s[4:7], s37 offen offset:1024
    v_mul_f32 v36, 0xbfb8aa3b, v100
    v_mul_f32 v37, 0xbfb8aa3b, v101
    v_mul_f32 v38, 0xbfb8aa3b, v102
    v_mul_f32 v39, 0xbfb8aa3b, v103
    v_exp_f32 v32, v32
    s_waitcnt lgkmcnt(5)
    v_mfma_f32_32x32x16_bf16 v[112:127], v[220:223], v[28:31], v[112:127]
    ds_read_b128 v[28:31], v4 offset:62464
    v_exp_f32 v33, v33
    v_exp_f32 v34, v34
    v_exp_f32 v35, v35
    v_exp_f32 v36, v36
    v_exp_f32 v37, v37
    s_waitcnt lgkmcnt(5)
    v_mfma_f32_32x32x16_bf16 v[112:127], v[224:227], v[8:11], v[112:127]
    ds_read_b128 v[8:11], v4 offset:63488
    buffer_load_dwordx4 v[176:179], v3, s[4:7], s37 offen offset:2048
    v_exp_f32 v38, v38
    v_exp_f32 v39, v39
    v_add_f32 v32, 1.0, v32
    v_add_f32 v33, 1.0, v33
    v_add_f32 v34, 1.0, v34
    s_waitcnt lgkmcnt(5)
    v_mfma_f32_32x32x16_bf16 v[112:127], v[228:231], v[12:15], v[112:127]
    ds_read_b128 v[12:15], v4 offset:64512
    v_add_f32 v35, 1.0, v35
    v_add_f32 v36, 1.0, v36
    v_add_f32 v37, 1.0, v37
    v_add_f32 v38, 1.0, v38
    v_add_f32 v39, 1.0, v39
    s_waitcnt lgkmcnt(5)
    v_mfma_f32_32x32x16_bf16 v[112:127], v[232:235], v[16:19], v[112:127]
    buffer_load_dwordx4 v[180:183], v7, s[4:7], s37 offen offset:2048
    v_rcp_f32 v32, v32
    v_rcp_f32 v33, v33
    v_rcp_f32 v34, v34
    v_rcp_f32 v35, v35
    v_rcp_f32 v36, v36
    s_waitcnt lgkmcnt(4)
    v_mfma_f32_32x32x16_bf16 v[112:127], v[236:239], v[20:23], v[112:127]
    v_rcp_f32 v37, v37
    v_rcp_f32 v38, v38
    v_rcp_f32 v39, v39
    v_mul_f32 v96, v96, v104
    v_mul_f32 v97, v97, v105
    s_waitcnt lgkmcnt(3)
    v_mfma_f32_32x32x16_bf16 v[112:127], v[240:243], v[24:27], v[112:127]
    v_mul_f32 v98, v98, v106
    v_mul_f32 v99, v99, v107
    v_mul_f32 v100, v100, v108
    v_mul_f32 v101, v101, v109
    v_mul_f32 v102, v102, v110
    s_waitcnt lgkmcnt(2)
    v_mfma_f32_32x32x16_bf16 v[112:127], v[244:247], v[28:31], v[112:127]
    s_waitcnt lgkmcnt(1)
    v_mfma_f32_32x32x16_bf16 v[112:127], v[248:251], v[8:11], v[112:127]
    s_waitcnt lgkmcnt(0)
    v_mfma_f32_32x32x16_bf16 v[112:127], v[252:255], v[12:15], v[112:127]
    v_mul_f32 v103, v103, v111
    v_mul_f32 v32, v32, v96
    v_mul_f32 v33, v33, v97
    v_mul_f32 v34, v34, v98
    v_mul_f32 v35, v35, v99
    v_mul_f32 v36, v36, v100
    v_mul_f32 v37, v37, v101
    v_mul_f32 v38, v38, v102
    v_mul_f32 v39, v39, v103
    v_cvt_pk_bf16_f32 v48, v32, v33
    v_cvt_pk_bf16_f32 v49, v34, v35
    v_cvt_pk_bf16_f32 v50, v36, v37
    v_cvt_pk_bf16_f32 v51, v38, v39
    buffer_store_dwordx4 v[48:51], v3, s[4:7], s25 offen sc0 sc1
    s_add_u32 s25, s25, 114688
    v_mul_f32 v32, 0xbfb8aa3b, v112
    v_mul_f32 v33, 0xbfb8aa3b, v113
    v_mul_f32 v34, 0xbfb8aa3b, v114
    v_mul_f32 v35, 0xbfb8aa3b, v115
    v_mul_f32 v36, 0xbfb8aa3b, v116
    v_mul_f32 v37, 0xbfb8aa3b, v117
    v_mul_f32 v38, 0xbfb8aa3b, v118
    v_mul_f32 v39, 0xbfb8aa3b, v119
    v_exp_f32 v32, v32
    v_exp_f32 v33, v33
    v_exp_f32 v34, v34
    v_exp_f32 v35, v35
    v_exp_f32 v36, v36
    v_exp_f32 v37, v37
    v_exp_f32 v38, v38
    v_exp_f32 v39, v39
    v_add_f32 v32, 1.0, v32
    v_add_f32 v33, 1.0, v33
    v_add_f32 v34, 1.0, v34
    v_add_f32 v35, 1.0, v35
    v_add_f32 v36, 1.0, v36
    v_add_f32 v37, 1.0, v37
    v_add_f32 v38, 1.0, v38
    v_add_f32 v39, 1.0, v39
    v_rcp_f32 v32, v32
    v_rcp_f32 v33, v33
    v_rcp_f32 v34, v34
    v_rcp_f32 v35, v35
    v_rcp_f32 v36, v36
    v_rcp_f32 v37, v37
    v_rcp_f32 v38, v38
    v_rcp_f32 v39, v39
    v_mul_f32 v112, v112, v120
    v_mul_f32 v113, v113, v121
    v_mul_f32 v114, v114, v122
    v_mul_f32 v115, v115, v123
    v_mul_f32 v116, v116, v124
    v_mul_f32 v117, v117, v125
    v_mul_f32 v118, v118, v126
    v_mul_f32 v119, v119, v127
    v_mul_f32 v32, v32, v112
    v_mul_f32 v33, v33, v113
    v_mul_f32 v34, v34, v114
    v_mul_f32 v35, v35, v115
    v_mul_f32 v36, v36, v116
    v_mul_f32 v37, v37, v117
    v_mul_f32 v38, v38, v118
    v_mul_f32 v39, v39, v119
    v_cvt_pk_bf16_f32 v52, v32, v33
    v_cvt_pk_bf16_f32 v53, v34, v35
    v_cvt_pk_bf16_f32 v54, v36, v37
    v_cvt_pk_bf16_f32 v55, v38, v39
    buffer_store_dwordx4 v[52:55], v3, s[4:7], s25 offen sc0 sc1
    s_waitcnt vmcnt(0)
    s_barrier
    s_cmp_lg_u32 s3, 0
    s_cbranch_scc1 k3_sy
    s_mov_b64 exec, 1
    s_lshl_b32 s48, s21, 4
    v_mov_b32 v8, s48
    v_mov_b32 v9, 1
    buffer_store_dword v9, v8, s[4:7], s44 offen sc0 sc1
    s_mov_b64 exec, -1
    s_branch k3_sy
k3_np:
    s_bfe_u32 s48, s2, 0x20003
    s_lshl_b32 s48, s48, 3
    s_add_u32 s48, s48, s3
    s_mul_i32 s48, s48, 57344
    s_add_u32 s48, s48, 0xcd0000
    v_lshlrev_b32 v4, 7, v1
    buffer_load_dword v252, v4, s[4:7], s48 offen
    s_add_u32 s48, s48, 8192
    s_waitcnt vmcnt(0)
    buffer_load_dword v252, v4, s[4:7], s48 offen
    s_add_u32 s48, s48, 8192
    s_waitcnt vmcnt(0)
    buffer_load_dword v252, v4, s[4:7], s48 offen
    s_add_u32 s48, s48, 8192
    s_waitcnt vmcnt(0)
    buffer_load_dword v252, v4, s[4:7], s48 offen
    s_add_u32 s48, s48, 8192
    s_waitcnt vmcnt(0)
    buffer_load_dword v252, v4, s[4:7], s48 offen
    s_add_u32 s48, s48, 8192
    s_waitcnt vmcnt(0)
    buffer_load_dword v252, v4, s[4:7], s48 offen
    s_add_u32 s48, s48, 8192
    s_waitcnt vmcnt(0)
    buffer_load_dword v252, v4, s[4:7], s48 offen
    s_add_u32 s48, s48, 8192
    s_waitcnt vmcnt(0)
    buffer_load_dwordx4 v[128:131], v3, s[4:7], s36 offen offset:0
    buffer_load_dwordx4 v[132:135], v7, s[4:7], s36 offen offset:0
    buffer_load_dwordx4 v[136:139], v3, s[4:7], s36 offen offset:1024
    buffer_load_dwordx4 v[140:143], v7, s[4:7], s36 offen offset:1024
    buffer_load_dwordx4 v[144:147], v3, s[4:7], s36 offen offset:2048
    buffer_load_dwordx4 v[148:151], v7, s[4:7], s36 offen offset:2048
    buffer_load_dwordx4 v[152:155], v3, s[4:7], s36 offen offset:3072
    buffer_load_dwordx4 v[156:159], v7, s[4:7], s36 offen offset:3072
    buffer_load_dwordx4 v[160:163], v3, s[4:7], s37 offen offset:0
    buffer_load_dwordx4 v[164:167], v7, s[4:7], s37 offen offset:0
    buffer_load_dwordx4 v[168:171], v3, s[4:7], s37 offen offset:1024
    buffer_load_dwordx4 v[172:175], v7, s[4:7], s37 offen offset:1024
    buffer_load_dwordx4 v[176:179], v3, s[4:7], s37 offen offset:2048
    buffer_load_dwordx4 v[180:183], v7, s[4:7], s37 offen offset:2048
k3_sy:
    v_min_u32 v4, 27, v1
    v_lshlrev_b32 v4, 7, v4
    buffer_load_dwordx4 v[56:59], v6, s[4:7], s46 offen
    buffer_load_dwordx4 v[60:63], v6, s[4:7], s46 offen offset:16
    s_cmp_eq_u32 s3, 0
    s_cbranch_scc1 k3_poll
    buffer_load_dwordx4 v[184:187], v3, s[4:7], s38 offen offset:0
    buffer_load_dwordx4 v[188:191], v7, s[4:7], s38 offen offset:0
    buffer_load_dwordx4 v[192:195], v3, s[4:7], s38 offen offset:1024
    buffer_load_dwordx4 v[196:199], v7, s[4:7], s38 offen offset:1024
    buffer_load_dwordx4 v[200:203], v3, s[4:7], s38 offen offset:2048
    buffer_load_dwordx4 v[204:207], v7, s[4:7], s38 offen offset:2048
    buffer_load_dwordx4 v[208:211], v3, s[4:7], s38 offen offset:3072
    buffer_load_dwordx4 v[212:215], v7, s[4:7], s38 offen offset:3072
    buffer_load_dwordx4 v[216:219], v3, s[4:7], s39 offen offset:0
    buffer_load_dwordx4 v[220:223], v7, s[4:7], s39 offen offset:0
    buffer_load_dwordx4 v[224:227], v3, s[4:7], s39 offen offset:1024
    buffer_load_dwordx4 v[228:231], v7, s[4:7], s39 offen offset:1024
    buffer_load_dwordx4 v[232:235], v3, s[4:7], s39 offen offset:2048
    buffer_load_dwordx4 v[236:239], v7, s[4:7], s39 offen offset:2048
    s_barrier
    s_branch k3_go
k3_poll:
    s_mov_b32 s48, 200000
    v_min_u32 v10, 13, v1
    v_lshlrev_b32 v10, 7, v10
k3_pl:
    buffer_load_dword v11, v10, s[4:7], s43 offen sc0 sc1
    s_sub_u32 s48, s48, 1
    s_cmp_eq_u32 s48, 0
    s_cbranch_scc1 k3_pd
    s_waitcnt vmcnt(0)
    v_cmp_eq_u32 vcc, 0, v11
    s_cbranch_vccnz k3_pl
k3_pd:
    s_waitcnt vmcnt(0)
    s_barrier
    buffer_load_dwordx4 v[184:187], v3, s[4:7], s38 offen offset:0
    buffer_load_dwordx4 v[188:191], v7, s[4:7], s38 offen offset:0
    buffer_load_dwordx4 v[192:195], v3, s[4:7], s38 offen offset:1024
    buffer_load_dwordx4 v[196:199], v7, s[4:7], s38 offen offset:1024
    buffer_load_dwordx4 v[200:203], v3, s[4:7], s38 offen offset:2048
    buffer_load_dwordx4 v[204:207], v7, s[4:7], s38 offen offset:2048
    buffer_load_dwordx4 v[208:211], v3, s[4:7], s38 offen offset:3072
    buffer_load_dwordx4 v[212:215], v7, s[4:7], s38 offen offset:3072
    buffer_load_dwordx4 v[216:219], v3, s[4:7], s39 offen offset:0
    buffer_load_dwordx4 v[220:223], v7, s[4:7], s39 offen offset:0
    buffer_load_dwordx4 v[224:227], v3, s[4:7], s39 offen offset:1024
    buffer_load_dwordx4 v[228:231], v7, s[4:7], s39 offen offset:1024
    buffer_load_dwordx4 v[232:235], v3, s[4:7], s39 offen offset:2048
    buffer_load_dwordx4 v[236:239], v7, s[4:7], s39 offen offset:2048
k3_go:
    buffer_load_dwordx4 v[52:55], v5, s[4:7], s47 offen
    buffer_load_dwordx4 v[8:11], v3, s[4:7], s32 offen offset:0
    buffer_load_dwordx4 v[12:15], v7, s[4:7], s32 offen offset:0
    buffer_load_dwordx4 v[16:19], v3, s[4:7], s32 offen offset:1024
    buffer_load_dwordx4 v[20:23], v7, s[4:7], s32 offen offset:1024
    buffer_load_dwordx4 v[24:27], v3, s[4:7], s32 offen offset:2048
    buffer_load_dwordx4 v[28:31], v7, s[4:7], s32 offen offset:2048
    buffer_load_dwordx4 v[32:35], v3, s[4:7], s32 offen offset:3072
    buffer_load_dwordx4 v[36:39], v7, s[4:7], s32 offen offset:3072
    buffer_load_dwordx4 v[40:43], v3, s[4:7], s33 offen offset:0
    buffer_load_dwordx4 v[44:47], v7, s[4:7], s33 offen offset:0
    buffer_load_dwordx4 v[48:51], v3, s[4:7], s33 offen offset:1024
    buffer_load_dwordx4 v[240:243], v7, s[4:7], s33 offen offset:1024
    buffer_load_dwordx4 v[244:247], v3, s[4:7], s33 offen offset:2048
    buffer_load_dwordx4 v[248:251], v7, s[4:7], s33 offen offset:2048
    s_waitcnt vmcnt(12)
    v_mfma_f32_32x32x16_bf16 v[64:79], v[128:131], v[8:11], 0
    v_mfma_f32_32x32x16_bf16 v[80:95], v[128:131], v[12:15], 0
    v_mfma_f32_32x32x16_bf16 v[96:111], v[132:135], v[8:11], 0
    v_mfma_f32_32x32x16_bf16 v[112:127], v[132:135], v[12:15], 0
    buffer_load_dwordx4 v[8:11], v3, s[4:7], s34 offen offset:0
    buffer_load_dwordx4 v[12:15], v7, s[4:7], s34 offen offset:0
    s_waitcnt vmcnt(12)
    v_mfma_f32_32x32x16_bf16 v[64:79], v[136:139], v[16:19], v[64:79]
    v_mfma_f32_32x32x16_bf16 v[80:95], v[136:139], v[20:23], v[80:95]
    v_mfma_f32_32x32x16_bf16 v[96:111], v[140:143], v[16:19], v[96:111]
    v_mfma_f32_32x32x16_bf16 v[112:127], v[140:143], v[20:23], v[112:127]
    buffer_load_dwordx4 v[16:19], v3, s[4:7], s34 offen offset:1024
    buffer_load_dwordx4 v[20:23], v7, s[4:7], s34 offen offset:1024
    s_waitcnt vmcnt(12)
    v_mfma_f32_32x32x16_bf16 v[64:79], v[144:147], v[24:27], v[64:79]
    v_mfma_f32_32x32x16_bf16 v[80:95], v[144:147], v[28:31], v[80:95]
    v_mfma_f32_32x32x16_bf16 v[96:111], v[148:151], v[24:27], v[96:111]
    v_mfma_f32_32x32x16_bf16 v[112:127], v[148:151], v[28:31], v[112:127]
    buffer_load_dwordx4 v[24:27], v3, s[4:7], s34 offen offset:2048
    buffer_load_dwordx4 v[28:31], v7, s[4:7], s34 offen offset:2048
    s_waitcnt vmcnt(12)
    v_mfma_f32_32x32x16_bf16 v[64:79], v[152:155], v[32:35], v[64:79]
    v_mfma_f32_32x32x16_bf16 v[80:95], v[152:155], v[36:39], v[80:95]
    v_mfma_f32_32x32x16_bf16 v[96:111], v[156:159], v[32:35], v[96:111]
    v_mfma_f32_32x32x16_bf16 v[112:127], v[156:159], v[36:39], v[112:127]
    buffer_load_dwordx4 v[32:35], v3, s[4:7], s34 offen offset:3072
    buffer_load_dwordx4 v[36:39], v7, s[4:7], s34 offen offset:3072
    s_waitcnt vmcnt(12)
    v_mfma_f32_32x32x16_bf16 v[64:79], v[160:163], v[40:43], v[64:79]
    v_mfma_f32_32x32x16_bf16 v[80:95], v[160:163], v[44:47], v[80:95]
    v_mfma_f32_32x32x16_bf16 v[96:111], v[164:167], v[40:43], v[96:111]
    v_mfma_f32_32x32x16_bf16 v[112:127], v[164:167], v[44:47], v[112:127]
    buffer_load_dwordx4 v[40:43], v3, s[4:7], s35 offen offset:0
    buffer_load_dwordx4 v[44:47], v7, s[4:7], s35 offen offset:0
    s_waitcnt vmcnt(12)
    v_mfma_f32_32x32x16_bf16 v[64:79], v[168:171], v[48:51], v[64:79]
    v_mfma_f32_32x32x16_bf16 v[80:95], v[168:171], v[240:243], v[80:95]
    v_mfma_f32_32x32x16_bf16 v[96:111], v[172:175], v[48:51], v[96:111]
    v_mfma_f32_32x32x16_bf16 v[112:127], v[172:175], v[240:243], v[112:127]
    buffer_load_dwordx4 v[48:51], v3, s[4:7], s35 offen offset:1024
    buffer_load_dwordx4 v[240:243], v7, s[4:7], s35 offen offset:1024
    s_waitcnt vmcnt(12)
    v_mfma_f32_32x32x16_bf16 v[64:79], v[176:179], v[244:247], v[64:79]
    v_mfma_f32_32x32x16_bf16 v[80:95], v[176:179], v[248:251], v[80:95]
    v_mfma_f32_32x32x16_bf16 v[96:111], v[180:183], v[244:247], v[96:111]
    v_mfma_f32_32x32x16_bf16 v[112:127], v[180:183], v[248:251], v[112:127]
    buffer_load_dwordx4 v[244:247], v3, s[4:7], s35 offen offset:2048
    buffer_load_dwordx4 v[248:251], v7, s[4:7], s35 offen offset:2048
    s_waitcnt vmcnt(12)
    v_mfma_f32_32x32x16_bf16 v[64:79], v[184:187], v[8:11], v[64:79]
    v_mfma_f32_32x32x16_bf16 v[80:95], v[184:187], v[12:15], v[80:95]
    v_mfma_f32_32x32x16_bf16 v[96:111], v[188:191], v[8:11], v[96:111]
    v_mfma_f32_32x32x16_bf16 v[112:127], v[188:191], v[12:15], v[112:127]
    s_waitcnt vmcnt(10)
    v_mfma_f32_32x32x16_bf16 v[64:79], v[192:195], v[16:19], v[64:79]
    v_mfma_f32_32x32x16_bf16 v[80:95], v[192:195], v[20:23], v[80:95]
    v_mfma_f32_32x32x16_bf16 v[96:111], v[196:199], v[16:19], v[96:111]
    v_mfma_f32_32x32x16_bf16 v[112:127], v[196:199], v[20:23], v[112:127]
    s_waitcnt vmcnt(8)
    v_mfma_f32_32x32x16_bf16 v[64:79], v[200:203], v[24:27], v[64:79]
    v_mfma_f32_32x32x16_bf16 v[80:95], v[200:203], v[28:31], v[80:95]
    v_mfma_f32_32x32x16_bf16 v[96:111], v[204:207], v[24:27], v[96:111]
    v_mfma_f32_32x32x16_bf16 v[112:127], v[204:207], v[28:31], v[112:127]
    s_waitcnt vmcnt(6)
    v_mfma_f32_32x32x16_bf16 v[64:79], v[208:211], v[32:35], v[64:79]
    v_mfma_f32_32x32x16_bf16 v[80:95], v[208:211], v[36:39], v[80:95]
    v_mfma_f32_32x32x16_bf16 v[96:111], v[212:215], v[32:35], v[96:111]
    v_mfma_f32_32x32x16_bf16 v[112:127], v[212:215], v[36:39], v[112:127]
    s_waitcnt vmcnt(4)
    v_mfma_f32_32x32x16_bf16 v[64:79], v[216:219], v[40:43], v[64:79]
    v_mfma_f32_32x32x16_bf16 v[80:95], v[216:219], v[44:47], v[80:95]
    v_mfma_f32_32x32x16_bf16 v[96:111], v[220:223], v[40:43], v[96:111]
    v_mfma_f32_32x32x16_bf16 v[112:127], v[220:223], v[44:47], v[112:127]
    s_waitcnt vmcnt(2)
    v_mfma_f32_32x32x16_bf16 v[64:79], v[224:227], v[48:51], v[64:79]
    v_mfma_f32_32x32x16_bf16 v[80:95], v[224:227], v[240:243], v[80:95]
    v_mfma_f32_32x32x16_bf16 v[96:111], v[228:231], v[48:51], v[96:111]
    v_mfma_f32_32x32x16_bf16 v[112:127], v[228:231], v[240:243], v[112:127]
    s_waitcnt vmcnt(0)
    v_mfma_f32_32x32x16_bf16 v[64:79], v[232:235], v[244:247], v[64:79]
    v_mfma_f32_32x32x16_bf16 v[80:95], v[232:235], v[248:251], v[80:95]
    v_mfma_f32_32x32x16_bf16 v[96:111], v[236:239], v[244:247], v[96:111]
    v_mfma_f32_32x32x16_bf16 v[112:127], v[236:239], v[248:251], v[112:127]
    s_lshl_b32 s22, s3, 10
    v_add_u32 v8, s22, v3
    v_add_u32 v9, 0x10000, v8
    s_lshl_b32 s22, s3, 14
    v_add_u32 v2, s22, v3
    v_lshlrev_b32 v128, 16, v52
    v_and_b32 v129, 0xffff0000, v52
    v_lshlrev_b32 v130, 16, v53
    v_and_b32 v131, 0xffff0000, v53
    v_lshlrev_b32 v132, 16, v54
    v_and_b32 v133, 0xffff0000, v54
    v_lshlrev_b32 v134, 16, v55
    v_and_b32 v135, 0xffff0000, v55
    s_nop 4
    ds_write_b128 v8, v[64:67] offset:0
    ds_write_b128 v8, v[68:71] offset:8192
    ds_write_b128 v8, v[72:75] offset:16384
    ds_write_b128 v8, v[76:79] offset:24576
    ds_write_b128 v8, v[80:83] offset:32768
    ds_write_b128 v8, v[84:87] offset:40960
    ds_write_b128 v8, v[88:91] offset:49152
    ds_write_b128 v8, v[92:95] offset:57344
    ds_write_b128 v9, v[96:99] offset:0
    ds_write_b128 v9, v[100:103] offset:8192
    ds_write_b128 v9, v[104:107] offset:16384
    ds_write_b128 v9, v[108:111] offset:24576
    s_nop 7
    ds_write_b128 v9, v[112:115] offset:32768
    ds_write_b128 v9, v[116:119] offset:40960
    ds_write_b128 v9, v[120:123] offset:49152
    ds_write_b128 v9, v[124:127] offset:57344
    s_waitcnt lgkmcnt(0)
    s_barrier
    ds_read_b128 v[64:67], v2 offset:0
    ds_read_b128 v[68:71], v2 offset:1024
    ds_read_b128 v[72:75], v2 offset:2048
    ds_read_b128 v[76:79], v2 offset:3072
    ds_read_b128 v[80:83], v2 offset:4096
    ds_read_b128 v[84:87], v2 offset:5120
    ds_read_b128 v[88:91], v2 offset:6144
    ds_read_b128 v[92:95], v2 offset:7168
    ds_read_b128 v[96:99], v2 offset:8192
    ds_read_b128 v[100:103], v2 offset:9216
    ds_read_b128 v[104:107], v2 offset:10240
    ds_read_b128 v[108:111], v2 offset:11264
    ds_read_b128 v[112:115], v2 offset:12288
    ds_read_b128 v[116:119], v2 offset:13312
    ds_read_b128 v[120:123], v2 offset:14336
    ds_read_b128 v[124:127], v2 offset:15360
    s_waitcnt lgkmcnt(12)
    v_add_f32 v64, v64, v68
    v_add_f32 v72, v72, v76
    v_add_f32 v65, v65, v69
    v_add_f32 v73, v73, v77
    v_add_f32 v66, v66, v70
    v_add_f32 v74, v74, v78
    v_add_f32 v67, v67, v71
    v_add_f32 v75, v75, v79
    s_waitcnt lgkmcnt(8)
    v_add_f32 v80, v80, v84
    v_add_f32 v88, v88, v92
    v_add_f32 v81, v81, v85
    v_add_f32 v89, v89, v93
    v_add_f32 v82, v82, v86
    v_add_f32 v90, v90, v94
    v_add_f32 v83, v83, v87
    v_add_f32 v91, v91, v95
    v_add_f32 v64, v64, v72
    v_add_f32 v80, v80, v88
    v_add_f32 v65, v65, v73
    v_add_f32 v81, v81, v89
    v_add_f32 v66, v66, v74
    v_add_f32 v82, v82, v90
    v_add_f32 v67, v67, v75
    v_add_f32 v83, v83, v91
    v_add_f32 v64, v64, v80
    v_add_f32 v65, v65, v81
    v_add_f32 v66, v66, v82
    v_add_f32 v67, v67, v83
    v_fmac_f32 v128, v64, v56
    v_fmac_f32 v129, v65, v57
    v_fmac_f32 v130, v66, v58
    v_fmac_f32 v131, v67, v59
    s_waitcnt lgkmcnt(4)
    v_add_f32 v96, v96, v100
    v_add_f32 v104, v104, v108
    v_add_f32 v97, v97, v101
    v_add_f32 v105, v105, v109
    v_add_f32 v98, v98, v102
    v_add_f32 v106, v106, v110
    v_add_f32 v99, v99, v103
    v_add_f32 v107, v107, v111
    s_waitcnt lgkmcnt(0)
    v_add_f32 v112, v112, v116
    v_add_f32 v120, v120, v124
    v_add_f32 v113, v113, v117
    v_add_f32 v121, v121, v125
    v_add_f32 v114, v114, v118
    v_add_f32 v122, v122, v126
    v_add_f32 v115, v115, v119
    v_add_f32 v123, v123, v127
    v_add_f32 v96, v96, v104
    v_add_f32 v112, v112, v120
    v_add_f32 v97, v97, v105
    v_add_f32 v113, v113, v121
    v_add_f32 v98, v98, v106
    v_add_f32 v114, v114, v122
    v_add_f32 v99, v99, v107
    v_add_f32 v115, v115, v123
    v_add_f32 v96, v96, v112
    v_add_f32 v97, v97, v113
    v_add_f32 v98, v98, v114
    v_add_f32 v99, v99, v115
    v_fmac_f32 v132, v96, v60
    v_fmac_f32 v133, v97, v61
    v_fmac_f32 v134, v98, v62
    v_fmac_f32 v135, v99, v63
    v_cvt_pk_bf16_f32 v136, v128, v129
    v_cvt_pk_bf16_f32 v137, v130, v131
    v_cvt_pk_bf16_f32 v138, v132, v133
    v_cvt_pk_bf16_f32 v139, v134, v135
    buffer_store_dwordx4 v[136:139], v5, s[8:11], s45 offen
k2_end:
    s_endpgm
k2_slow:
    v_subrev_u32 v92, 126720, v92
    v_mov_b32 v72, 0xff800000
    v_mov_b32 v73, 0xff800000
    s_mov_b32 s41, 0x520000
k2_s1:
    buffer_load_dwordx4 v[80:83], v3, s[4:7], s41 offen
    s_waitcnt vmcnt(0)
    v_mfma_f32_32x32x16_bf16 v[24:39], v[80:83], v[4:7], 0
    s_add_u32 s41, s41, 2112
    s_nop 11
    v_max3_f32 v72, v24, v25, v72
    v_max3_f32 v72, v26, v27, v72
    v_max3_f32 v72, v28, v29, v72
    v_max3_f32 v72, v30, v31, v72
    v_max3_f32 v72, v32, v33, v72
    v_max3_f32 v72, v34, v35, v72
    v_max3_f32 v72, v36, v37, v72
    v_max3_f32 v72, v38, v39, v72
    s_cmp_lt_u32 s41, 0x541000
    s_cbranch_scc1 k2_s1
    v_max_f32 v72, v72, v73
    v_mov_b32 v73, v72
    s_nop 1
    v_permlane32_swap_b32 v72, v73
    s_nop 1
    v_max_f32 v72, v72, v73
    v_sub_f32 v8, 0, v72
    v_mov_b32 v9, v8
    v_mov_b32 v10, v8
    v_mov_b32 v11, v8
    v_mov_b32 v12, v8
    v_mov_b32 v13, v8
    v_mov_b32 v14, v8
    v_mov_b32 v15, v8
    v_mov_b32 v16, v8
    v_mov_b32 v17, v8
    v_mov_b32 v18, v8
    v_mov_b32 v19, v8
    v_mov_b32 v20, v8
    v_mov_b32 v21, v8
    v_mov_b32 v22, v8
    v_mov_b32 v23, v8
    v_mov_b32 v56, 0
    v_mov_b32 v57, 0
    v_mov_b32 v58, 0
    v_mov_b32 v59, 0
    v_mov_b32 v60, 0
    v_mov_b32 v61, 0
    v_mov_b32 v62, 0
    v_mov_b32 v63, 0
    v_mov_b32 v64, 0
    v_mov_b32 v65, 0
    v_mov_b32 v66, 0
    v_mov_b32 v67, 0
    v_mov_b32 v68, 0
    v_mov_b32 v69, 0
    v_mov_b32 v70, 0
    v_mov_b32 v71, 0
    s_mov_b32 s41, 0x520000
k2_s2:
    buffer_load_dwordx4 v[80:83], v3, s[4:7], s41 offen
    buffer_load_dwordx4 v[84:87], v92, s[4:7], s41 offen
    buffer_load_dwordx4 v[88:91], v92, s[4:7], s41 offen offset:544
    s_waitcnt vmcnt(0)
    v_mfma_f32_32x32x16_bf16 v[24:39], v[80:83], v[4:7], v[8:23]
    s_add_u32 s41, s41, 2112
    s_nop 11
    v_exp_f32 v24, v24
    v_exp_f32 v25, v25
    v_exp_f32 v26, v26
    v_exp_f32 v27, v27
    v_exp_f32 v28, v28
    v_exp_f32 v29, v29
    v_exp_f32 v30, v30
    v_exp_f32 v31, v31
    v_exp_f32 v32, v32
    v_exp_f32 v33, v33
    v_exp_f32 v34, v34
    v_exp_f32 v35, v35
    v_exp_f32 v36, v36
    v_exp_f32 v37, v37
    v_exp_f32 v38, v38
    v_exp_f32 v39, v39
    v_cvt_pk_bf16_f32 v72, v24, v25
    v_cvt_pk_bf16_f32 v73, v26, v27
    v_cvt_pk_bf16_f32 v74, v28, v29
    v_cvt_pk_bf16_f32 v75, v30, v31
    v_cvt_pk_bf16_f32 v76, v32, v33
    v_cvt_pk_bf16_f32 v77, v34, v35
    v_cvt_pk_bf16_f32 v78, v36, v37
    v_cvt_pk_bf16_f32 v79, v38, v39
    s_nop 1
    v_mfma_f32_32x32x16_bf16 v[56:71], v[84:87], v[72:75], v[56:71]
    v_mfma_f32_32x32x16_bf16 v[56:71], v[88:91], v[76:79], v[56:71]
    s_cmp_lt_u32 s41, 0x541000
    s_nop 7
    s_cbranch_scc1 k2_s2
    s_nop 7
    s_branch k2_tail
.section .rodata,"a"
.p2align 6
.amdhsa_kernel k1_kernel
  .amdhsa_next_free_vgpr 256
  .amdhsa_next_free_sgpr 96
  .amdhsa_accum_offset 256
  .amdhsa_group_segment_fixed_size 0
  .amdhsa_kernarg_size 112
  .amdhsa_user_sgpr_count 2
  .amdhsa_user_sgpr_kernarg_segment_ptr 1
  .amdhsa_system_sgpr_workgroup_id_x 1
.end_amdhsa_kernel
.p2align 6
.amdhsa_kernel k2_kernel
  .amdhsa_next_free_vgpr 256
  .amdhsa_next_free_sgpr 96
  .amdhsa_accum_offset 256
  .amdhsa_group_segment_fixed_size 0
  .amdhsa_kernarg_size 112
  .amdhsa_user_sgpr_count 2
  .amdhsa_user_sgpr_kernarg_segment_ptr 1
  .amdhsa_system_sgpr_workgroup_id_x 1
.end_amdhsa_kernel
```
